```python
import torch

def _softmax(x, axis=-1):
    return torch.softmax(x, dim=axis)
def _gelu(x):
    return torch.nn.functional.gelu(x, approximate="tanh")
def _silu(x):
    return torch.nn.functional.silu(x)
def _sigmoid(x):
    return torch.sigmoid(x)
def _layernorm(x, axis=-1, eps=1e-5):
    m = x.mean(dim=axis, keepdim=True)
    v = x.var(dim=axis, keepdim=True, unbiased=False)
    return (x - m) / torch.sqrt(v + eps)
def _scatter_add(tgt, idx, src, axis=0):
    return tgt.clone().index_add_(axis, idx, src)
def _segment_sum(src, seg, n):
    out = torch.zeros((n,) + src.shape[1:], dtype=src.dtype)
    return out.index_add_(0, seg, src)
def _pad(x, pw):
    flat = tuple(v for pair in reversed(pw) for v in pair)
    return torch.nn.functional.pad(x, flat)

kernel_name = 'concat_heads__grouped_kv_mqa__spectral_fnet__prompt'

def setup_inputs():

    _w = (lambda a: (lambda t: t.to(torch.bfloat16) if t.is_floating_point() else t)(torch.as_tensor(a)))
    def _A_setup():
        B, S, D, H = 1, 2048, 448, 16
        Dh = D // H
        return {
            "x": _w((lambda *s: torch.randn(*s, dtype=torch.bfloat16) * 0.05)(B, S, D)),
            "wq": _w((lambda *s: torch.randn(*s, dtype=torch.bfloat16) * 3.2)(D, H * Dh)),
            "wk": _w((lambda *s: torch.randn(*s, dtype=torch.bfloat16) * 3.2)(D, Dh)),
            "wv": _w((lambda *s: torch.randn(*s, dtype=torch.bfloat16) * 0.4)(D, Dh)),
            "wo": _w((lambda *s: torch.randn(*s, dtype=torch.bfloat16) * 0.4)(H * Dh, D)),
        }
    _A_in = _A_setup()

    def _B_setup():
        B, S, D = 1, 2048, 448
        ns = torch.arange(S)[:, None] * torch.arange(S)[None, :]
        nd = torch.arange(D)[:, None] * torch.arange(D)[None, :]
        Ws_re = torch.cos(-2.0 * torch.pi * ns / S).to(float)
        Ws_im = torch.sin(-2.0 * torch.pi * ns / S).to(float)
        Wd_re = torch.cos(-2.0 * torch.pi * nd / D).to(float)
        Wd_im = torch.sin(-2.0 * torch.pi * nd / D).to(float)
        return {
            "x": _w((lambda *s: torch.randn(*s, dtype=torch.bfloat16) * 0.05)(B, S, D)),
            "dft_seq_re": _w(Ws_re),
            "dft_seq_im": _w(Ws_im),
            "dft_hid_re": _w(Wd_re),
            "dft_hid_im": _w(Wd_im),
        }
    _B_in = _B_setup()

    return {
        "A_x": _A_in["x"],
        "A_wq": _A_in["wq"],
        "A_wk": _A_in["wk"],
        "A_wv": _A_in["wv"],
        "A_wo": _A_in["wo"],
        "B_x": _B_in["x"],
        "B_dft_seq_re": _B_in["dft_seq_re"],
        "B_dft_seq_im": _B_in["dft_seq_im"],
        "B_dft_hid_re": _B_in["dft_hid_re"],
        "B_dft_hid_im": _B_in["dft_hid_im"],
    }

def reference(A_x, A_wq, A_wk, A_wv, A_wo, B_x, B_dft_seq_re, B_dft_seq_im, B_dft_hid_re, B_dft_hid_im):
    def _A_ref(x, wq, wk, wv, wo):
        B, S, D = x.shape
        H = 16
        Dh = D // H
        q = (lambda x, *d: x.permute(*d))((x @ wq).reshape(B, S, H, Dh), 0, 2, 1, 3)
        k = x @ wk
        v = x @ wv
        scores = torch.einsum("bhqd,bkd->bhqk", q, k) * (Dh ** -0.5)
        p = _softmax(scores, axis=-1)
        o = torch.einsum("bhqk,bkd->bhqd", p, v)
        return (lambda x, *d: x.permute(*d))(o, 0, 2, 1, 3).reshape(B, S, H * Dh) @ wo

    def _B_ref(x, dft_seq_re, dft_seq_im, dft_hid_re, dft_hid_im):
        a = torch.einsum("bsd,ed->bse", x, dft_hid_re)
        b = torch.einsum("bsd,ed->bse", x, dft_hid_im)
        y = torch.einsum("ts,bse->bte", dft_seq_re, a) - torch.einsum("ts,bse->bte", dft_seq_im, b)
        return y

    a = _A_ref(A_x, A_wq, A_wk, A_wv, A_wo)
    b = _B_ref(B_x, B_dft_seq_re, B_dft_seq_im, B_dft_hid_re, B_dft_hid_im)
    return torch.concatenate([a, b], axis=-1)
```

```asm
; @launch grid=(256,1,1) block=(256,1,1) lds=163840
.amdgcn_target "amdgcn-amd-amdhsa--gfx950"
.text
.globl concat_heads__grouped_kv_mqa__spectral_fnet__prompt_kernel
.p2align 8
.type concat_heads__grouped_kv_mqa__spectral_fnet__prompt_kernel,@function
concat_heads__grouped_kv_mqa__spectral_fnet__prompt_kernel:
    s_cmp_ge_u32 s2, 256
    s_cbranch_scc1 L_end
    s_load_dwordx8 s[4:11], s[0:1], 0
    s_load_dwordx4 s[12:15], s[0:1], 32
    s_load_dwordx4 s[16:19], s[0:1], 80
    s_load_dwordx2 s[20:21], s[0:1], 96
    v_lshrrev_b32 v5, 6, v0
    v_and_b32 v0, 63, v0
    v_readfirstlane_b32 s22, v5
    v_lshlrev_b32 v1, 4, v0
    s_and_b32 s23, s2, 7
    s_bfe_u32 s24, s2, 0x30003
    s_lshr_b32 s25, s2, 6
    s_lshl2_add_u32 s26, s23, s25
    s_and_b32 s28, s24, 3
    s_lshl3_add_u32 s27, s23, s24
    s_mov_b32 s29, 0xffffff
    s_lshl2_add_u32 s68, s28, s22
    s_mul_i32 s31, s68, 3584
    s_mul_i32 s68, s68, 3648
    v_add_u32 v248, s31, v1
    s_mul_i32 s69, s22, 6272
    s_bitcmp1_b32 s25, 0
    s_cselect_b32 s63, 0, 3584
    s_cselect_b32 s31, 2688, 0
    s_add_u32 s63, s63, s69
    s_add_u32 s69, s69, s31
    v_add_u32 v249, s69, v1
    v_add_u32 v250, s63, v1
    s_lshl2_add_u32 s30, s25, s22
    s_mul_i32 s70, s26, 57344
    s_mul_i32 s71, s27, 896
    s_mov_b32 m0, s68
    v_mov_b32 v112, 0
    v_and_b32 v206, 31, v0
    v_lshrrev_b32 v207, 5, v0
    v_bfe_u32 v210, v0, 4, 1
    v_and_b32 v208, 3, v0
    v_and_b32 v90, 7, v0
    v_lshl_add_u32 v90, v210, 3, v90
    s_lshl_b32 s31, s30, 4
    s_cmp_lt_u32 s30, 14
    s_cbranch_scc1 L_reg
    v_lshrrev_b32 v90, 2, v90
    v_add_u32 v91, -1, v208
    v_and_b32 v91, 31, v91
    v_lshl_add_u32 v90, v90, 5, v91
    s_lshl_b32 s31, s31, 3
    s_addk_i32 s31, -1791
L_reg:
    v_add_u32 v90, s31, v90
    v_cvt_f32_u32 v90, v90
    v_mul_f32 v90, 0x3b124925, v90
    v_bfe_u32 v91, v0, 3, 1
    v_cvt_f32_u32 v91, v91
    v_mul_f32 v91, 0x3e800000, v91
    v_cvt_f32_u32 v92, v207
    v_mul_f32 v93, 0x41000000, v92
    v_fma_f32 v72, v90, v93, v91
    v_add_f32 v73, v72, v90
    v_add_f32 v74, v73, v90
    v_add_f32 v75, v74, v90
    v_add_f32 v76, v75, v90
    v_add_f32 v77, v76, v90
    v_add_f32 v78, v77, v90
    v_add_f32 v79, v78, v90
    v_mul_f32 v88, 0x41800000, v90
    v_add_f32 v80, v72, v88
    v_add_f32 v81, v73, v88
    v_add_f32 v82, v74, v88
    v_add_f32 v83, v75, v88
    v_add_f32 v84, v76, v88
    v_add_f32 v85, v77, v88
    v_add_f32 v86, v78, v88
    v_add_f32 v87, v79, v88
    v_cos_f32 v88, v88
    v_cos_f32 v72, v72
    v_cos_f32 v73, v73
    v_cos_f32 v74, v74
    v_cos_f32 v75, v75
    s_cmp_ge_u32 s24, 4
    s_mov_b32 exec_hi, s29
    s_waitcnt lgkmcnt(0)
    s_cselect_b64 s[8:9], s[10:11], s[8:9]
    s_add_u32 s4, s4, s70
    s_addc_u32 s5, s5, 0
    global_load_lds_dwordx4 v248, s[4:5] offset:0
    s_add_u32 m0, s68, 16
    s_add_u32 s14, s14, s71
    s_addc_u32 s15, s15, 0
    global_load_lds_dwordx4 v248, s[4:5] offset:896
    s_add_u32 m0, s68, 32
    s_nop 0
    global_load_lds_dwordx4 v248, s[4:5] offset:1792
    s_add_u32 m0, s68, 48
    s_nop 0
    global_load_lds_dwordx4 v248, s[4:5] offset:2688
    s_add_u32 m0, s69, 137728
    s_nop 0
    global_load_lds_dwordx4 v249, s[8:9] offset:0
    global_load_lds_dwordx4 v249, s[8:9] offset:896
    global_load_lds_dwordx4 v249, s[8:9] offset:1792
    global_load_lds_dwordx4 v249, s[8:9] offset:2688
    s_add_u32 m0, s63, 137728
    s_nop 0
    global_load_lds_dwordx4 v250, s[8:9] offset:0
    global_load_lds_dwordx4 v250, s[8:9] offset:896
    global_load_lds_dwordx4 v250, s[8:9] offset:1792
    s_mov_b32 exec_hi, -1
    v_cos_f32 v76, v76
    v_cos_f32 v77, v77
    v_cos_f32 v78, v78
    v_cos_f32 v79, v79
    v_cos_f32 v80, v80
    v_cos_f32 v81, v81
    v_cos_f32 v82, v82
    v_cos_f32 v83, v83
    v_cos_f32 v84, v84
    v_cos_f32 v85, v85
    v_cos_f32 v86, v86
    v_cos_f32 v87, v87
    v_add_f32 v88, v88, v88
    v_mul_u32_u24 v225, 37, v0
    v_lshrrev_b32 v225, 8, v225
    v_mul_u32_u24 v226, 112, v225
    v_sub_u32 v226, v1, v226
    v_and_b32 v227, 3, v225
    v_lshrrev_b32 v225, 2, v225
    v_lshl_add_u32 v227, v227, 2, v225
    s_movk_i32 s31, 896
    v_mad_u32_u24 v226, v227, s31, v226
    s_lshl3_add_u32 s35, s25, s22
    s_mul_i32 s34, s35, 14336
    s_mul_i32 s31, s24, 112
    s_add_u32 s31, s31, s34
    v_add_u32 v223, s31, v226
    s_mul_i32 s62, s35, 1792
    s_add_u32 s62, s62, 58368
    s_mov_b32 s38, 57344
    s_mul_i32 s34, s22, 25
    v_min_u32 v225, 24, v0
    v_add_u32 v225, s34, v225
    v_min_u32 v225, 97, v225
    s_lshr_b32 s34, s2, 3
    s_mulk_i32 s34, 98
    v_add_lshl_u32 v9, v225, s34, 7
    v_bfe_u32 v209, v0, 2, 2
    v_and_b32 v211, 15, v0
    v_lshrrev_b32 v212, 4, v0
    v_lshl_add_u32 v90, v212, 3, v209
    v_mul_u32_u24 v90, 56, v90
    v_lshl_add_u32 v90, v208, 3, v90
    s_cmp_ge_u32 s24, 4
    s_cselect_b32 s31, 24, 32
    s_mul_i32 s31, s31, s22
    s_add_u32 s31, s31, 137728
    v_add_u32 v213, s31, v90
    s_movk_i32 s39, 912
    s_mul_i32 s31, s28, 14592
    v_lshl_add_u32 v90, v212, 4, s31
    v_mad_u32_u24 v214, v211, s39, v90
    v_lshlrev_b32 v91, 4, v207
    v_mad_u32_u24 v218, v206, s39, v91
    v_add_u32 v215, 108544, v218
    s_lshr_b32 s32, s22, 1
    s_and_b32 s33, s22, 1
    s_lshl_b32 s64, s25, 6
    s_add_u32 s64, s64, s27
    s_mul_i32 s34, s64, 384
    s_lshl2_add_u32 s34, s22, s34
    s_add_u32 s59, s34, 65536
    v_mov_b32 v5, s59
    s_lshl3_add_u32 s31, s25, s23
    s_lshr_b32 s34, s28, 1
    s_lshl1_add_u32 s31, s31, s34
    s_lshl_b32 s31, s31, 12
    s_add_u32 s60, s31, 262144
    s_and_b32 s61, s28, 1
    v_mov_b32 v8, v5
    s_addk_i32 s59, 128
    v_writelane_b32 v8, s59, 62
    global_load_dword v8, v8, s[20:21]
    v_cvt_pk_bf16_f32 v128, v72, v73
    v_cvt_pk_bf16_f32 v129, v74, v75
    v_cvt_pk_bf16_f32 v130, v76, v77
    v_cvt_pk_bf16_f32 v131, v78, v79
    v_cvt_pk_bf16_f32 v132, v80, v81
    v_cvt_pk_bf16_f32 v133, v82, v83
    v_cvt_pk_bf16_f32 v134, v84, v85
    v_cvt_pk_bf16_f32 v135, v86, v87
    v_pk_fma_f32 v[72:73], v[80:81], v[88:89], v[72:73] op_sel_hi:[1,0,1] neg_lo:[0,0,1] neg_hi:[0,0,1]
    v_pk_fma_f32 v[74:75], v[82:83], v[88:89], v[74:75] op_sel_hi:[1,0,1] neg_lo:[0,0,1] neg_hi:[0,0,1]
    v_pk_fma_f32 v[76:77], v[84:85], v[88:89], v[76:77] op_sel_hi:[1,0,1] neg_lo:[0,0,1] neg_hi:[0,0,1]
    v_pk_fma_f32 v[78:79], v[86:87], v[88:89], v[78:79] op_sel_hi:[1,0,1] neg_lo:[0,0,1] neg_hi:[0,0,1]
    v_cvt_pk_bf16_f32 v136, v72, v73
    v_cvt_pk_bf16_f32 v137, v74, v75
    v_cvt_pk_bf16_f32 v138, v76, v77
    v_cvt_pk_bf16_f32 v139, v78, v79
    v_pk_fma_f32 v[80:81], v[72:73], v[88:89], v[80:81] op_sel_hi:[1,0,1] neg_lo:[0,0,1] neg_hi:[0,0,1]
    v_pk_fma_f32 v[82:83], v[74:75], v[88:89], v[82:83] op_sel_hi:[1,0,1] neg_lo:[0,0,1] neg_hi:[0,0,1]
    v_pk_fma_f32 v[84:85], v[76:77], v[88:89], v[84:85] op_sel_hi:[1,0,1] neg_lo:[0,0,1] neg_hi:[0,0,1]
    v_pk_fma_f32 v[86:87], v[78:79], v[88:89], v[86:87] op_sel_hi:[1,0,1] neg_lo:[0,0,1] neg_hi:[0,0,1]
    v_cvt_pk_bf16_f32 v140, v80, v81
    v_cvt_pk_bf16_f32 v141, v82, v83
    v_cvt_pk_bf16_f32 v142, v84, v85
    v_cvt_pk_bf16_f32 v143, v86, v87
    v_pk_fma_f32 v[72:73], v[80:81], v[88:89], v[72:73] op_sel_hi:[1,0,1] neg_lo:[0,0,1] neg_hi:[0,0,1]
    v_pk_fma_f32 v[74:75], v[82:83], v[88:89], v[74:75] op_sel_hi:[1,0,1] neg_lo:[0,0,1] neg_hi:[0,0,1]
    v_pk_fma_f32 v[76:77], v[84:85], v[88:89], v[76:77] op_sel_hi:[1,0,1] neg_lo:[0,0,1] neg_hi:[0,0,1]
    v_pk_fma_f32 v[78:79], v[86:87], v[88:89], v[78:79] op_sel_hi:[1,0,1] neg_lo:[0,0,1] neg_hi:[0,0,1]
    v_cvt_pk_bf16_f32 v144, v72, v73
    v_cvt_pk_bf16_f32 v145, v74, v75
    v_cvt_pk_bf16_f32 v146, v76, v77
    v_cvt_pk_bf16_f32 v147, v78, v79
    v_pk_fma_f32 v[80:81], v[72:73], v[88:89], v[80:81] op_sel_hi:[1,0,1] neg_lo:[0,0,1] neg_hi:[0,0,1]
    v_pk_fma_f32 v[82:83], v[74:75], v[88:89], v[82:83] op_sel_hi:[1,0,1] neg_lo:[0,0,1] neg_hi:[0,0,1]
    v_pk_fma_f32 v[84:85], v[76:77], v[88:89], v[84:85] op_sel_hi:[1,0,1] neg_lo:[0,0,1] neg_hi:[0,0,1]
    v_pk_fma_f32 v[86:87], v[78:79], v[88:89], v[86:87] op_sel_hi:[1,0,1] neg_lo:[0,0,1] neg_hi:[0,0,1]
    v_cvt_pk_bf16_f32 v148, v80, v81
    v_cvt_pk_bf16_f32 v149, v82, v83
    v_cvt_pk_bf16_f32 v150, v84, v85
    v_cvt_pk_bf16_f32 v151, v86, v87
    v_pk_fma_f32 v[72:73], v[80:81], v[88:89], v[72:73] op_sel_hi:[1,0,1] neg_lo:[0,0,1] neg_hi:[0,0,1]
    v_pk_fma_f32 v[74:75], v[82:83], v[88:89], v[74:75] op_sel_hi:[1,0,1] neg_lo:[0,0,1] neg_hi:[0,0,1]
    v_pk_fma_f32 v[76:77], v[84:85], v[88:89], v[76:77] op_sel_hi:[1,0,1] neg_lo:[0,0,1] neg_hi:[0,0,1]
    v_pk_fma_f32 v[78:79], v[86:87], v[88:89], v[78:79] op_sel_hi:[1,0,1] neg_lo:[0,0,1] neg_hi:[0,0,1]
    v_cvt_pk_bf16_f32 v152, v72, v73
    v_cvt_pk_bf16_f32 v153, v74, v75
    v_cvt_pk_bf16_f32 v154, v76, v77
    v_cvt_pk_bf16_f32 v155, v78, v79
    v_pk_fma_f32 v[80:81], v[72:73], v[88:89], v[80:81] op_sel_hi:[1,0,1] neg_lo:[0,0,1] neg_hi:[0,0,1]
    v_pk_fma_f32 v[82:83], v[74:75], v[88:89], v[82:83] op_sel_hi:[1,0,1] neg_lo:[0,0,1] neg_hi:[0,0,1]
    v_pk_fma_f32 v[84:85], v[76:77], v[88:89], v[84:85] op_sel_hi:[1,0,1] neg_lo:[0,0,1] neg_hi:[0,0,1]
    v_pk_fma_f32 v[86:87], v[78:79], v[88:89], v[86:87] op_sel_hi:[1,0,1] neg_lo:[0,0,1] neg_hi:[0,0,1]
    v_cvt_pk_bf16_f32 v156, v80, v81
    v_cvt_pk_bf16_f32 v157, v82, v83
    v_cvt_pk_bf16_f32 v158, v84, v85
    v_cvt_pk_bf16_f32 v159, v86, v87
    v_pk_fma_f32 v[72:73], v[80:81], v[88:89], v[72:73] op_sel_hi:[1,0,1] neg_lo:[0,0,1] neg_hi:[0,0,1]
    v_pk_fma_f32 v[74:75], v[82:83], v[88:89], v[74:75] op_sel_hi:[1,0,1] neg_lo:[0,0,1] neg_hi:[0,0,1]
    v_pk_fma_f32 v[76:77], v[84:85], v[88:89], v[76:77] op_sel_hi:[1,0,1] neg_lo:[0,0,1] neg_hi:[0,0,1]
    v_pk_fma_f32 v[78:79], v[86:87], v[88:89], v[78:79] op_sel_hi:[1,0,1] neg_lo:[0,0,1] neg_hi:[0,0,1]
    v_cvt_pk_bf16_f32 v160, v72, v73
    v_cvt_pk_bf16_f32 v161, v74, v75
    v_cvt_pk_bf16_f32 v162, v76, v77
    v_cvt_pk_bf16_f32 v163, v78, v79
    v_pk_fma_f32 v[80:81], v[72:73], v[88:89], v[80:81] op_sel_hi:[1,0,1] neg_lo:[0,0,1] neg_hi:[0,0,1]
    v_pk_fma_f32 v[82:83], v[74:75], v[88:89], v[82:83] op_sel_hi:[1,0,1] neg_lo:[0,0,1] neg_hi:[0,0,1]
    v_pk_fma_f32 v[84:85], v[76:77], v[88:89], v[84:85] op_sel_hi:[1,0,1] neg_lo:[0,0,1] neg_hi:[0,0,1]
    v_pk_fma_f32 v[86:87], v[78:79], v[88:89], v[86:87] op_sel_hi:[1,0,1] neg_lo:[0,0,1] neg_hi:[0,0,1]
    v_cvt_pk_bf16_f32 v164, v80, v81
    v_cvt_pk_bf16_f32 v165, v82, v83
    v_cvt_pk_bf16_f32 v166, v84, v85
    v_cvt_pk_bf16_f32 v167, v86, v87
    v_pk_fma_f32 v[72:73], v[80:81], v[88:89], v[72:73] op_sel_hi:[1,0,1] neg_lo:[0,0,1] neg_hi:[0,0,1]
    v_pk_fma_f32 v[74:75], v[82:83], v[88:89], v[74:75] op_sel_hi:[1,0,1] neg_lo:[0,0,1] neg_hi:[0,0,1]
    v_pk_fma_f32 v[76:77], v[84:85], v[88:89], v[76:77] op_sel_hi:[1,0,1] neg_lo:[0,0,1] neg_hi:[0,0,1]
    v_pk_fma_f32 v[78:79], v[86:87], v[88:89], v[78:79] op_sel_hi:[1,0,1] neg_lo:[0,0,1] neg_hi:[0,0,1]
    v_cvt_pk_bf16_f32 v168, v72, v73
    v_cvt_pk_bf16_f32 v169, v74, v75
    v_cvt_pk_bf16_f32 v170, v76, v77
    v_cvt_pk_bf16_f32 v171, v78, v79
    v_pk_fma_f32 v[80:81], v[72:73], v[88:89], v[80:81] op_sel_hi:[1,0,1] neg_lo:[0,0,1] neg_hi:[0,0,1]
    v_pk_fma_f32 v[82:83], v[74:75], v[88:89], v[82:83] op_sel_hi:[1,0,1] neg_lo:[0,0,1] neg_hi:[0,0,1]
    v_pk_fma_f32 v[84:85], v[76:77], v[88:89], v[84:85] op_sel_hi:[1,0,1] neg_lo:[0,0,1] neg_hi:[0,0,1]
    v_pk_fma_f32 v[86:87], v[78:79], v[88:89], v[86:87] op_sel_hi:[1,0,1] neg_lo:[0,0,1] neg_hi:[0,0,1]
    v_cvt_pk_bf16_f32 v172, v80, v81
    v_cvt_pk_bf16_f32 v173, v82, v83
    v_cvt_pk_bf16_f32 v174, v84, v85
    v_cvt_pk_bf16_f32 v175, v86, v87
    v_pk_fma_f32 v[72:73], v[80:81], v[88:89], v[72:73] op_sel_hi:[1,0,1] neg_lo:[0,0,1] neg_hi:[0,0,1]
    v_pk_fma_f32 v[74:75], v[82:83], v[88:89], v[74:75] op_sel_hi:[1,0,1] neg_lo:[0,0,1] neg_hi:[0,0,1]
    v_pk_fma_f32 v[76:77], v[84:85], v[88:89], v[76:77] op_sel_hi:[1,0,1] neg_lo:[0,0,1] neg_hi:[0,0,1]
    v_pk_fma_f32 v[78:79], v[86:87], v[88:89], v[78:79] op_sel_hi:[1,0,1] neg_lo:[0,0,1] neg_hi:[0,0,1]
    v_cvt_pk_bf16_f32 v176, v72, v73
    v_cvt_pk_bf16_f32 v177, v74, v75
    v_cvt_pk_bf16_f32 v178, v76, v77
    v_cvt_pk_bf16_f32 v179, v78, v79
    v_pk_fma_f32 v[80:81], v[72:73], v[88:89], v[80:81] op_sel_hi:[1,0,1] neg_lo:[0,0,1] neg_hi:[0,0,1]
    v_pk_fma_f32 v[82:83], v[74:75], v[88:89], v[82:83] op_sel_hi:[1,0,1] neg_lo:[0,0,1] neg_hi:[0,0,1]
    v_pk_fma_f32 v[84:85], v[76:77], v[88:89], v[84:85] op_sel_hi:[1,0,1] neg_lo:[0,0,1] neg_hi:[0,0,1]
    v_pk_fma_f32 v[86:87], v[78:79], v[88:89], v[86:87] op_sel_hi:[1,0,1] neg_lo:[0,0,1] neg_hi:[0,0,1]
    v_cvt_pk_bf16_f32 v180, v80, v81
    v_cvt_pk_bf16_f32 v181, v82, v83
    v_cvt_pk_bf16_f32 v182, v84, v85
    v_cvt_pk_bf16_f32 v183, v86, v87
    v_bfe_u32 v230, v0, 2, 1
    v_bfe_u32 v231, v0, 3, 2
    v_lshl_add_u32 v230, v230, 2, v231
    v_lshl_add_u32 v230, v230, 2, v208
    s_lshl_b32 s31, s33, 5
    v_add_u32 v240, s31, v230
    global_load_dword v4, v112, s[20:21] sc1
    s_mov_b32 exec_hi, s29
    s_xor_b32 s68, s30, 0
    s_mul_i32 s69, s68, 114688
    s_mul_i32 m0, s68, 1824
    v_add_u32 v248, s69, v1
    s_add_u32 m0, m0, 108544
    v_add_u32 v249, 56432, v248
    global_load_lds_dwordx4 v248, s[14:15]
    global_load_lds_dwordx4 v249, s[14:15] offset:912
    s_mov_b32 exec_hi, -1
    s_mov_b32 exec_hi, s29
    s_mov_b32 exec_hi, -1
    v_cvt_f32_u32 v240, v240
    v_cvt_f32_u32 v241, v207
    v_mul_f32 v240, 0x3c800000, v240
    v_mul_f32 v241, 4.0, v241
    v_mul_f32 v242, 0x41000000, v240
    v_mul_f32 v57, v240, v241
    v_add_f32 v59, v57, v240
    v_add_f32 v65, v57, v242
    v_add_f32 v67, v59, v242
    v_cos_f32 v240, v240
    v_cos_f32 v242, v242
    v_cos_f32 v56, v57
    v_sin_f32 v57, v57
    v_cos_f32 v58, v59
    v_sin_f32 v59, v59
    v_cos_f32 v64, v65
    v_sin_f32 v65, v65
    v_cos_f32 v66, v67
    v_sin_f32 v67, v67
    v_add_f32 v240, v240, v240
    s_mov_b32 exec_hi, s29
    s_xor_b32 s68, s30, 4
    s_mul_i32 s69, s68, 114688
    s_mul_i32 m0, s68, 1824
    v_add_u32 v248, s69, v1
    s_add_u32 m0, m0, 108544
    v_add_u32 v249, 56432, v248
    global_load_lds_dwordx4 v248, s[14:15]
    global_load_lds_dwordx4 v249, s[14:15] offset:912
    s_xor_b32 s68, s30, 8
    s_mul_i32 s69, s68, 114688
    s_mul_i32 m0, s68, 1824
    v_add_u32 v248, s69, v1
    s_add_u32 m0, m0, 108544
    v_add_u32 v249, 56432, v248
    global_load_lds_dwordx4 v248, s[14:15]
    global_load_lds_dwordx4 v249, s[14:15] offset:912
    s_xor_b32 s68, s30, 12
    s_mul_i32 s69, s68, 114688
    s_mul_i32 m0, s68, 1824
    v_add_u32 v248, s69, v1
    s_add_u32 m0, m0, 108544
    v_add_u32 v249, 56432, v248
    global_load_lds_dwordx4 v248, s[14:15]
    global_load_lds_dwordx4 v249, s[14:15] offset:912
    s_mov_b32 exec_hi, -1
    s_cmp_ge_u32 s22, 2
    s_waitcnt vmcnt(10)
    s_barrier
    s_cbranch_scc1 L_xrest
    s_cmp_ge_u32 s24, 4
    s_cbranch_scc1 L_vproj
    ds_read_b128 a[128:131], v214 offset:0
    ds_read_b64_tr_b16 a[72:73], v213 offset:0
    ds_read_b64_tr_b16 a[74:75], v213 offset:224
    ds_read_b128 a[132:135], v214 offset:64
    ds_read_b64_tr_b16 a[76:77], v213 offset:1792
    ds_read_b64_tr_b16 a[78:79], v213 offset:2016
    ds_read_b128 a[136:139], v214 offset:128
    ds_read_b64_tr_b16 a[80:81], v213 offset:3584
    ds_read_b64_tr_b16 a[82:83], v213 offset:3808
    ds_read_b128 a[140:143], v214 offset:192
    ds_read_b64_tr_b16 a[84:85], v213 offset:5376
    ds_read_b64_tr_b16 a[86:87], v213 offset:5600
    ds_read_b128 a[144:147], v214 offset:256
    ds_read_b64_tr_b16 a[88:89], v213 offset:7168
    ds_read_b64_tr_b16 a[90:91], v213 offset:7392
    v_lshlrev_b32 v104, 9, v207
    s_lshl2_add_u32 s63, s22, s61
    s_lshl_b32 s63, s63, 8
    s_add_u32 s63, s63, s60
    v_lshl_add_u32 v104, v211, 4, v104
    s_mov_b32 s66, 0x3e8b97f6
    v_add_u32 v104, s63, v104
    s_mov_b32 s68, 0xffff
    s_mov_b32 s69, s68
    s_cmp_eq_u32 s22, 1
    s_cselect_b32 s71, 0xffff0000, 0
    s_mov_b32 s70, 0
    s_waitcnt lgkmcnt(12)
    v_mfma_f32_16x16x32_bf16 v[96:99], a[72:75], a[128:131], 0
    ds_read_b128 a[148:151], v214 offset:320
    ds_read_b64_tr_b16 a[92:93], v213 offset:8960
    ds_read_b64_tr_b16 a[94:95], v213 offset:9184
    s_waitcnt lgkmcnt(12)
    v_mfma_f32_16x16x32_bf16 v[100:103], a[76:79], a[132:135], 0
    ds_read_b128 a[152:155], v214 offset:384
    ds_read_b64_tr_b16 a[96:97], v213 offset:10752
    ds_read_b64_tr_b16 a[98:99], v213 offset:10976
    s_waitcnt lgkmcnt(12)
    v_mfma_f32_16x16x32_bf16 v[96:99], a[80:83], a[136:139], v[96:99]
    ds_read_b128 a[156:159], v214 offset:448
    ds_read_b64_tr_b16 a[100:101], v213 offset:12544
    ds_read_b64_tr_b16 a[102:103], v213 offset:12768
    s_waitcnt lgkmcnt(12)
    v_mfma_f32_16x16x32_bf16 v[100:103], a[84:87], a[140:143], v[100:103]
    ds_read_b128 a[160:163], v214 offset:512
    ds_read_b64_tr_b16 a[104:105], v213 offset:14336
    ds_read_b64_tr_b16 a[106:107], v213 offset:14560
    s_waitcnt lgkmcnt(12)
    v_mfma_f32_16x16x32_bf16 v[96:99], a[88:91], a[144:147], v[96:99]
    ds_read_b128 a[164:167], v214 offset:576
    ds_read_b64_tr_b16 a[108:109], v213 offset:16128
    ds_read_b64_tr_b16 a[110:111], v213 offset:16352
    s_waitcnt lgkmcnt(12)
    v_mfma_f32_16x16x32_bf16 v[100:103], a[92:95], a[148:151], v[100:103]
    ds_read_b128 a[168:171], v214 offset:640
    ds_read_b64_tr_b16 a[112:113], v213 offset:17920
    ds_read_b64_tr_b16 a[114:115], v213 offset:18144
    s_waitcnt lgkmcnt(12)
    v_mfma_f32_16x16x32_bf16 v[96:99], a[96:99], a[152:155], v[96:99]
    ds_read_b128 a[172:175], v214 offset:704
    ds_read_b64_tr_b16 a[116:117], v213 offset:19712
    ds_read_b64_tr_b16 a[118:119], v213 offset:19936
    s_waitcnt lgkmcnt(12)
    v_mfma_f32_16x16x32_bf16 v[100:103], a[100:103], a[156:159], v[100:103]
    ds_read_b128 a[176:179], v214 offset:768
    ds_read_b64_tr_b16 a[120:121], v213 offset:21504
    ds_read_b64_tr_b16 a[122:123], v213 offset:21728
    s_waitcnt lgkmcnt(12)
    v_mfma_f32_16x16x32_bf16 v[96:99], a[104:107], a[160:163], v[96:99]
    ds_read_b128 a[180:183], v214 offset:832
    ds_read_b64_tr_b16 a[124:125], v213 offset:23296
    ds_read_b64_tr_b16 a[126:127], v213 offset:23520
    s_waitcnt lgkmcnt(12)
    v_mfma_f32_16x16x32_bf16 v[100:103], a[108:111], a[164:167], v[100:103]
    s_waitcnt lgkmcnt(9)
    v_mfma_f32_16x16x32_bf16 v[96:99], a[112:115], a[168:171], v[96:99]
    s_waitcnt lgkmcnt(6)
    v_mfma_f32_16x16x32_bf16 v[100:103], a[116:119], a[172:175], v[100:103]
    s_waitcnt lgkmcnt(3)
    v_mfma_f32_16x16x32_bf16 v[96:99], a[120:123], a[176:179], v[96:99]
    s_waitcnt lgkmcnt(0)
    v_mfma_f32_16x16x32_bf16 v[100:103], a[124:127], a[180:183], v[100:103]
    s_nop 7
    v_add_f32 v96, v96, v100
    v_add_f32 v97, v97, v101
    v_add_f32 v98, v98, v102
    v_add_f32 v99, v99, v103
    v_mul_f32 v96, s66, v96
    v_mul_f32 v97, s66, v97
    v_mul_f32 v98, s66, v98
    v_mul_f32 v99, s66, v99
    v_cvt_pk_bf16_f32 v100, v96, v97
    v_cvt_pk_bf16_f32 v101, v98, v99
    s_mov_b64 exec, s[70:71]
    v_mov_b32 v100, 0x3f80
    v_mov_b32 v101, 0
    s_mov_b64 exec, -1
    v_mov_b64 v[102:103], v[100:101]
    s_nop 1
    v_permlane16_swap_b32 v100, v102
    v_permlane16_swap_b32 v101, v103
    s_mov_b64 exec, s[68:69]
    global_store_dwordx4 v104, v[100:103], s[20:21] sc1
    s_mov_b64 exec, -1
    s_branch L_kvj
L_vproj:
    ds_read_b128 a[128:131], v214 offset:0
    ds_read_b64_tr_b16 a[72:73], v213 offset:0
    ds_read_b64_tr_b16 a[74:75], v213 offset:224
    ds_read_b128 a[132:135], v214 offset:64
    ds_read_b64_tr_b16 a[76:77], v213 offset:1792
    ds_read_b64_tr_b16 a[78:79], v213 offset:2016
    ds_read_b128 a[136:139], v214 offset:128
    ds_read_b64_tr_b16 a[80:81], v213 offset:3584
    ds_read_b64_tr_b16 a[82:83], v213 offset:3808
    ds_read_b128 a[140:143], v214 offset:192
    ds_read_b64_tr_b16 a[84:85], v213 offset:5376
    ds_read_b64_tr_b16 a[86:87], v213 offset:5600
    ds_read_b128 a[144:147], v214 offset:256
    ds_read_b64_tr_b16 a[88:89], v213 offset:7168
    ds_read_b64_tr_b16 a[90:91], v213 offset:7392
    v_lshlrev_b32 v104, 9, v207
    s_lshl2_add_u32 s63, s61, s22
    s_lshl_b32 s63, s63, 8
    s_add_u32 s63, s63, s60
    s_addk_i32 s63, 2048
    s_lshl_b32 s66, s22, 3
    v_xor_b32 v105, s66, v211
    v_lshl_add_u32 v104, v105, 4, v104
    s_lshr_b32 s70, 0x11001100, s66
    v_add_u32 v104, s63, v104
    s_mov_b32 s68, 0xffff
    s_mov_b32 s69, s68
    s_cmp_eq_u32 s22, 1
    s_mov_b32 s71, s70
    s_waitcnt lgkmcnt(12)
    v_mfma_f32_16x16x32_bf16 v[96:99], a[128:131], a[72:75], 0
    ds_read_b128 a[148:151], v214 offset:320
    ds_read_b64_tr_b16 a[92:93], v213 offset:8960
    ds_read_b64_tr_b16 a[94:95], v213 offset:9184
    s_waitcnt lgkmcnt(12)
    v_mfma_f32_16x16x32_bf16 v[100:103], a[132:135], a[76:79], 0
    ds_read_b128 a[152:155], v214 offset:384
    ds_read_b64_tr_b16 a[96:97], v213 offset:10752
    ds_read_b64_tr_b16 a[98:99], v213 offset:10976
    s_waitcnt lgkmcnt(12)
    v_mfma_f32_16x16x32_bf16 v[96:99], a[136:139], a[80:83], v[96:99]
    ds_read_b128 a[156:159], v214 offset:448
    ds_read_b64_tr_b16 a[100:101], v213 offset:12544
    ds_read_b64_tr_b16 a[102:103], v213 offset:12768
    s_waitcnt lgkmcnt(12)
    v_mfma_f32_16x16x32_bf16 v[100:103], a[140:143], a[84:87], v[100:103]
    ds_read_b128 a[160:163], v214 offset:512
    ds_read_b64_tr_b16 a[104:105], v213 offset:14336
    ds_read_b64_tr_b16 a[106:107], v213 offset:14560
    s_waitcnt lgkmcnt(12)
    v_mfma_f32_16x16x32_bf16 v[96:99], a[144:147], a[88:91], v[96:99]
    ds_read_b128 a[164:167], v214 offset:576
    ds_read_b64_tr_b16 a[108:109], v213 offset:16128
    ds_read_b64_tr_b16 a[110:111], v213 offset:16352
    s_waitcnt lgkmcnt(12)
    v_mfma_f32_16x16x32_bf16 v[100:103], a[148:151], a[92:95], v[100:103]
    ds_read_b128 a[168:171], v214 offset:640
    ds_read_b64_tr_b16 a[112:113], v213 offset:17920
    ds_read_b64_tr_b16 a[114:115], v213 offset:18144
    s_waitcnt lgkmcnt(12)
    v_mfma_f32_16x16x32_bf16 v[96:99], a[152:155], a[96:99], v[96:99]
    ds_read_b128 a[172:175], v214 offset:704
    ds_read_b64_tr_b16 a[116:117], v213 offset:19712
    ds_read_b64_tr_b16 a[118:119], v213 offset:19936
    s_waitcnt lgkmcnt(12)
    v_mfma_f32_16x16x32_bf16 v[100:103], a[156:159], a[100:103], v[100:103]
    ds_read_b128 a[176:179], v214 offset:768
    ds_read_b64_tr_b16 a[120:121], v213 offset:21504
    ds_read_b64_tr_b16 a[122:123], v213 offset:21728
    s_waitcnt lgkmcnt(12)
    v_mfma_f32_16x16x32_bf16 v[96:99], a[160:163], a[104:107], v[96:99]
    ds_read_b128 a[180:183], v214 offset:832
    ds_read_b64_tr_b16 a[124:125], v213 offset:23296
    ds_read_b64_tr_b16 a[126:127], v213 offset:23520
    s_waitcnt lgkmcnt(12)
    v_mfma_f32_16x16x32_bf16 v[100:103], a[164:167], a[108:111], v[100:103]
    s_waitcnt lgkmcnt(9)
    v_mfma_f32_16x16x32_bf16 v[96:99], a[168:171], a[112:115], v[96:99]
    s_waitcnt lgkmcnt(6)
    v_mfma_f32_16x16x32_bf16 v[100:103], a[172:175], a[116:119], v[100:103]
    s_waitcnt lgkmcnt(3)
    v_mfma_f32_16x16x32_bf16 v[96:99], a[176:179], a[120:123], v[96:99]
    s_waitcnt lgkmcnt(0)
    v_mfma_f32_16x16x32_bf16 v[100:103], a[180:183], a[124:127], v[100:103]
    s_nop 7
    v_add_f32 v96, v96, v100
    v_add_f32 v97, v97, v101
    v_add_f32 v98, v98, v102
    v_add_f32 v99, v99, v103
    v_cvt_pk_bf16_f32 v100, v96, v97
    v_cvt_pk_bf16_f32 v101, v98, v99
    s_cbranch_scc1 L_v1
    v_mov_b32_dpp v100, v100 row_shr:2 row_mask:0xf bank_mask:8
    v_mov_b32_dpp v101, v101 row_shr:2 row_mask:0xf bank_mask:8
    s_nop 0
    v_mov_b32_dpp v100, v100 row_shr:1 row_mask:0xf bank_mask:4
    v_mov_b32_dpp v101, v101 row_shr:1 row_mask:0xf bank_mask:4
    s_branch L_v2
L_v1:
    s_nop 0
    v_mov_b32_dpp v100, v100 row_shl:1 row_mask:0xf bank_mask:1
    v_mov_b32_dpp v101, v101 row_shl:1 row_mask:0xf bank_mask:1
L_v2:
    s_mov_b64 exec, s[70:71]
    v_mov_b32 v100, 0x3f803f80
    v_mov_b32 v101, 0x3f803f80
    s_mov_b64 exec, -1
    v_mov_b64 v[102:103], v[100:101]
    s_nop 1
    v_permlane16_swap_b32 v100, v102
    v_permlane16_swap_b32 v101, v103
    s_mov_b64 exec, s[68:69]
    global_store_dwordx4 v104, v[100:103], s[20:21] sc1
    s_mov_b64 exec, -1
L_kvj:
    v_add_f32 v242, v242, v242
    v_pk_fma_f32 v[60:61], v[58:59], v[240:241], v[56:57] op_sel_hi:[1,0,1] neg_lo:[0,0,1] neg_hi:[0,0,1]
    v_pk_fma_f32 v[68:69], v[66:67], v[240:241], v[64:65] op_sel_hi:[1,0,1] neg_lo:[0,0,1] neg_hi:[0,0,1]
    v_pk_fma_f32 v[62:63], v[60:61], v[240:241], v[58:59] op_sel_hi:[1,0,1] neg_lo:[0,0,1] neg_hi:[0,0,1]
    v_pk_fma_f32 v[70:71], v[68:69], v[240:241], v[66:67] op_sel_hi:[1,0,1] neg_lo:[0,0,1] neg_hi:[0,0,1]
    v_cvt_pk_bf16_f32 v40, v56, v57
    v_cvt_pk_bf16_f32 v41, v58, v59
    v_cvt_pk_bf16_f32 v42, v60, v61
    v_cvt_pk_bf16_f32 v43, v62, v63
    v_cvt_pk_bf16_f32 v44, v64, v65
    v_cvt_pk_bf16_f32 v45, v66, v67
    v_cvt_pk_bf16_f32 v46, v68, v69
    v_cvt_pk_bf16_f32 v47, v70, v71
    v_pk_fma_f32 v[56:57], v[64:65], v[242:243], v[56:57] op_sel_hi:[1,0,1] neg_lo:[0,0,1] neg_hi:[0,0,1]
    v_pk_fma_f32 v[58:59], v[66:67], v[242:243], v[58:59] op_sel_hi:[1,0,1] neg_lo:[0,0,1] neg_hi:[0,0,1]
    v_pk_fma_f32 v[60:61], v[68:69], v[242:243], v[60:61] op_sel_hi:[1,0,1] neg_lo:[0,0,1] neg_hi:[0,0,1]
    v_pk_fma_f32 v[62:63], v[70:71], v[242:243], v[62:63] op_sel_hi:[1,0,1] neg_lo:[0,0,1] neg_hi:[0,0,1]
    v_cvt_pk_bf16_f32 v48, v56, v57
    v_cvt_pk_bf16_f32 v49, v58, v59
    v_cvt_pk_bf16_f32 v50, v60, v61
    v_cvt_pk_bf16_f32 v51, v62, v63
    v_pk_fma_f32 v[64:65], v[56:57], v[242:243], v[64:65] op_sel_hi:[1,0,1] neg_lo:[0,0,1] neg_hi:[0,0,1]
    v_pk_fma_f32 v[66:67], v[58:59], v[242:243], v[66:67] op_sel_hi:[1,0,1] neg_lo:[0,0,1] neg_hi:[0,0,1]
    v_pk_fma_f32 v[68:69], v[60:61], v[242:243], v[68:69] op_sel_hi:[1,0,1] neg_lo:[0,0,1] neg_hi:[0,0,1]
    v_pk_fma_f32 v[70:71], v[62:63], v[242:243], v[70:71] op_sel_hi:[1,0,1] neg_lo:[0,0,1] neg_hi:[0,0,1]
    v_cvt_pk_bf16_f32 v52, v64, v65
    v_cvt_pk_bf16_f32 v53, v66, v67
    v_cvt_pk_bf16_f32 v54, v68, v69
    v_cvt_pk_bf16_f32 v55, v70, v71
    v_mov_b32 v113, 0
    v_mov_b64 v[114:115], 0
    v_lshlrev_b32 v116, 31, v0
    v_lshrrev_b32 v118, 16, v116
    v_mfma_f32_32x32x16_bf16 a[0:15], v[112:115], v[112:115], 0
    v_or_b32 v118, v118, v116
    v_or_b32 v116, 1.0, v116
    v_cvt_f32_u32 v230, v206
    v_lshl_add_u32 v231, v207, 8, s27
    v_cvt_f32_u32 v231, v231
    v_mul_f32 v230, 0x3d000000, v230
    v_mul_f32 v231, 0x3c800000, v231
    v_mfma_f32_32x32x16_bf16 a[16:31], v[112:115], v[112:115], 0
    v_mul_f32 v232, v230, v231
    v_add_f32 v233, v232, v230
    v_add_f32 v234, v233, v230
    v_add_f32 v235, v234, v230
    v_fmamk_f32 v236, v230, 0x41000000, v232
    v_add_f32 v237, v236, v230
    v_add_f32 v238, v237, v230
    v_add_f32 v239, v238, v230
    v_mfma_f32_32x32x16_bf16 a[32:47], v[112:115], v[112:115], 0
    v_sin_f32 v240, v232
    v_sin_f32 v241, v233
    v_sin_f32 v242, v234
    v_sin_f32 v243, v235
    v_sin_f32 v244, v236
    v_sin_f32 v245, v237
    v_sin_f32 v246, v238
    v_sin_f32 v247, v239
    v_cos_f32 v232, v232
    v_cos_f32 v233, v233
    v_cos_f32 v234, v234
    v_cos_f32 v235, v235
    v_cos_f32 v236, v236
    v_cos_f32 v237, v237
    v_cos_f32 v238, v238
    v_cos_f32 v239, v239
    v_cvt_pk_bf16_f32 v20, v240, v241
    v_cvt_pk_bf16_f32 v21, v242, v243
    v_cvt_pk_bf16_f32 v22, v244, v245
    v_cvt_pk_bf16_f32 v23, v246, v247
    v_cvt_pk_bf16_f32 v16, v232, v233
    v_cvt_pk_bf16_f32 v17, v234, v235
    v_cvt_pk_bf16_f32 v18, v236, v237
    v_cvt_pk_bf16_f32 v19, v238, v239
    v_xor_b32 v24, v118, v16
    v_xor_b32 v25, v118, v17
    v_xor_b32 v26, v118, v18
    v_xor_b32 v27, v118, v19
    v_xor_b32 v28, v118, v20
    v_xor_b32 v29, v118, v21
    v_xor_b32 v30, v118, v22
    v_xor_b32 v31, v118, v23
    v_mul_u32_u24 v230, 272, v206
    s_lshl_b32 s31, s22, 6
    s_add_u32 s31, s31, 137728
    v_lshl_add_u32 v231, v207, 4, s31
    v_add_u32 v200, v230, v231
    s_mul_i32 s31, s32, 29184
    s_lshl_b32 s34, s25, 8
    s_add_u32 s31, s31, s34
    v_add_u32 v218, s31, v218
    v_lshl_add_u32 v230, v209, 1, v207
    v_mul_u32_u24 v230, 224, v230
    v_and_b32 v204, 1, v0
    v_bfe_u32 v205, v0, 1, 1
    v_lshl_add_u32 v231, v210, 1, v204
    v_lshl_add_u32 v231, v231, 1, v205
    v_lshl_add_u32 v230, v231, 3, v230
    s_waitcnt vmcnt(1)
    s_branch L_join
L_xrest:
    v_add_f32 v242, v242, v242
    v_pk_fma_f32 v[60:61], v[58:59], v[240:241], v[56:57] op_sel_hi:[1,0,1] neg_lo:[0,0,1] neg_hi:[0,0,1]
    v_pk_fma_f32 v[68:69], v[66:67], v[240:241], v[64:65] op_sel_hi:[1,0,1] neg_lo:[0,0,1] neg_hi:[0,0,1]
    v_pk_fma_f32 v[62:63], v[60:61], v[240:241], v[58:59] op_sel_hi:[1,0,1] neg_lo:[0,0,1] neg_hi:[0,0,1]
    v_pk_fma_f32 v[70:71], v[68:69], v[240:241], v[66:67] op_sel_hi:[1,0,1] neg_lo:[0,0,1] neg_hi:[0,0,1]
    v_cvt_pk_bf16_f32 v40, v56, v57
    v_cvt_pk_bf16_f32 v41, v58, v59
    v_cvt_pk_bf16_f32 v42, v60, v61
    v_cvt_pk_bf16_f32 v43, v62, v63
    v_cvt_pk_bf16_f32 v44, v64, v65
    v_cvt_pk_bf16_f32 v45, v66, v67
    v_cvt_pk_bf16_f32 v46, v68, v69
    v_cvt_pk_bf16_f32 v47, v70, v71
    v_pk_fma_f32 v[56:57], v[64:65], v[242:243], v[56:57] op_sel_hi:[1,0,1] neg_lo:[0,0,1] neg_hi:[0,0,1]
    v_pk_fma_f32 v[58:59], v[66:67], v[242:243], v[58:59] op_sel_hi:[1,0,1] neg_lo:[0,0,1] neg_hi:[0,0,1]
    v_pk_fma_f32 v[60:61], v[68:69], v[242:243], v[60:61] op_sel_hi:[1,0,1] neg_lo:[0,0,1] neg_hi:[0,0,1]
    v_pk_fma_f32 v[62:63], v[70:71], v[242:243], v[62:63] op_sel_hi:[1,0,1] neg_lo:[0,0,1] neg_hi:[0,0,1]
    v_cvt_pk_bf16_f32 v48, v56, v57
    v_cvt_pk_bf16_f32 v49, v58, v59
    v_cvt_pk_bf16_f32 v50, v60, v61
    v_cvt_pk_bf16_f32 v51, v62, v63
    v_pk_fma_f32 v[64:65], v[56:57], v[242:243], v[64:65] op_sel_hi:[1,0,1] neg_lo:[0,0,1] neg_hi:[0,0,1]
    v_pk_fma_f32 v[66:67], v[58:59], v[242:243], v[66:67] op_sel_hi:[1,0,1] neg_lo:[0,0,1] neg_hi:[0,0,1]
    v_pk_fma_f32 v[68:69], v[60:61], v[242:243], v[68:69] op_sel_hi:[1,0,1] neg_lo:[0,0,1] neg_hi:[0,0,1]
    v_pk_fma_f32 v[70:71], v[62:63], v[242:243], v[70:71] op_sel_hi:[1,0,1] neg_lo:[0,0,1] neg_hi:[0,0,1]
    v_cvt_pk_bf16_f32 v52, v64, v65
    v_cvt_pk_bf16_f32 v53, v66, v67
    v_cvt_pk_bf16_f32 v54, v68, v69
    v_cvt_pk_bf16_f32 v55, v70, v71
    v_mov_b32 v113, 0
    v_mov_b64 v[114:115], 0
    v_lshlrev_b32 v116, 31, v0
    v_lshrrev_b32 v118, 16, v116
    v_mfma_f32_32x32x16_bf16 a[0:15], v[112:115], v[112:115], 0
    v_or_b32 v118, v118, v116
    v_or_b32 v116, 1.0, v116
    v_cvt_f32_u32 v230, v206
    v_lshl_add_u32 v231, v207, 8, s27
    v_cvt_f32_u32 v231, v231
    v_mul_f32 v230, 0x3d000000, v230
    v_mul_f32 v231, 0x3c800000, v231
    v_mfma_f32_32x32x16_bf16 a[16:31], v[112:115], v[112:115], 0
    v_mul_f32 v232, v230, v231
    v_add_f32 v233, v232, v230
    v_add_f32 v234, v233, v230
    v_add_f32 v235, v234, v230
    v_fmamk_f32 v236, v230, 0x41000000, v232
    v_add_f32 v237, v236, v230
    v_add_f32 v238, v237, v230
    v_add_f32 v239, v238, v230
    v_mfma_f32_32x32x16_bf16 a[32:47], v[112:115], v[112:115], 0
    v_sin_f32 v240, v232
    v_sin_f32 v241, v233
    v_sin_f32 v242, v234
    v_sin_f32 v243, v235
    v_sin_f32 v244, v236
    v_sin_f32 v245, v237
    v_sin_f32 v246, v238
    v_sin_f32 v247, v239
    v_cos_f32 v232, v232
    v_cos_f32 v233, v233
    v_cos_f32 v234, v234
    v_cos_f32 v235, v235
    v_cos_f32 v236, v236
    v_cos_f32 v237, v237
    v_cos_f32 v238, v238
    v_cos_f32 v239, v239
    v_cvt_pk_bf16_f32 v20, v240, v241
    v_cvt_pk_bf16_f32 v21, v242, v243
    v_cvt_pk_bf16_f32 v22, v244, v245
    v_cvt_pk_bf16_f32 v23, v246, v247
    v_cvt_pk_bf16_f32 v16, v232, v233
    v_cvt_pk_bf16_f32 v17, v234, v235
    v_cvt_pk_bf16_f32 v18, v236, v237
    v_cvt_pk_bf16_f32 v19, v238, v239
    v_xor_b32 v24, v118, v16
    v_xor_b32 v25, v118, v17
    v_xor_b32 v26, v118, v18
    v_xor_b32 v27, v118, v19
    v_xor_b32 v28, v118, v20
    v_xor_b32 v29, v118, v21
    v_xor_b32 v30, v118, v22
    v_xor_b32 v31, v118, v23
    v_mul_u32_u24 v230, 272, v206
    s_lshl_b32 s31, s22, 6
    s_add_u32 s31, s31, 137728
    v_lshl_add_u32 v231, v207, 4, s31
    v_add_u32 v200, v230, v231
    s_mul_i32 s31, s32, 29184
    s_lshl_b32 s34, s25, 8
    s_add_u32 s31, s31, s34
    v_add_u32 v218, s31, v218
    v_lshl_add_u32 v230, v209, 1, v207
    v_mul_u32_u24 v230, 224, v230
    v_and_b32 v204, 1, v0
    v_bfe_u32 v205, v0, 1, 1
    v_lshl_add_u32 v231, v210, 1, v204
    v_lshl_add_u32 v231, v231, 1, v205
    v_lshl_add_u32 v230, v231, 3, v230
    s_xor_b32 s68, s28, 1
    s_lshl1_add_u32 s68, s68, s33
    s_mul_i32 s69, s68, 7168
    s_mul_i32 m0, s68, 7296
    v_add_u32 v248, s69, v1
    v_add_u32 v249, 3584, v248
    s_mov_b32 exec_hi, s29
    global_load_lds_dwordx4 v248, s[4:5] offset:0
    s_addk_i32 m0, 16
    s_nop 0
    global_load_lds_dwordx4 v248, s[4:5] offset:896
    s_addk_i32 m0, 16
    s_nop 0
    global_load_lds_dwordx4 v248, s[4:5] offset:1792
    s_addk_i32 m0, 16
    s_nop 0
    global_load_lds_dwordx4 v248, s[4:5] offset:2688
    s_addk_i32 m0, 3600
    s_nop 0
    global_load_lds_dwordx4 v249, s[4:5] offset:0
    s_addk_i32 m0, 16
    s_nop 0
    global_load_lds_dwordx4 v249, s[4:5] offset:896
    s_addk_i32 m0, 16
    s_nop 0
    global_load_lds_dwordx4 v249, s[4:5] offset:1792
    s_addk_i32 m0, 16
    s_nop 0
    global_load_lds_dwordx4 v249, s[4:5] offset:2688
    s_mov_b32 exec_hi, -1
    s_xor_b32 s68, s28, 2
    s_lshl1_add_u32 s68, s68, s33
    s_mul_i32 s69, s68, 7168
    s_mul_i32 m0, s68, 7296
    v_add_u32 v248, s69, v1
    v_add_u32 v249, 3584, v248
    s_mov_b32 exec_hi, s29
    global_load_lds_dwordx4 v248, s[4:5] offset:0
    s_addk_i32 m0, 16
    s_nop 0
    global_load_lds_dwordx4 v248, s[4:5] offset:896
    s_addk_i32 m0, 16
    s_nop 0
    global_load_lds_dwordx4 v248, s[4:5] offset:1792
    s_addk_i32 m0, 16
    s_nop 0
    global_load_lds_dwordx4 v248, s[4:5] offset:2688
    s_addk_i32 m0, 3600
    s_nop 0
    global_load_lds_dwordx4 v249, s[4:5] offset:0
    s_addk_i32 m0, 16
    s_nop 0
    global_load_lds_dwordx4 v249, s[4:5] offset:896
    s_addk_i32 m0, 16
    s_nop 0
    global_load_lds_dwordx4 v249, s[4:5] offset:1792
    s_addk_i32 m0, 16
    s_nop 0
    global_load_lds_dwordx4 v249, s[4:5] offset:2688
    s_mov_b32 exec_hi, -1
    s_xor_b32 s68, s28, 3
    s_lshl1_add_u32 s68, s68, s33
    s_mul_i32 s69, s68, 7168
    s_mul_i32 m0, s68, 7296
    v_add_u32 v248, s69, v1
    v_add_u32 v249, 3584, v248
    s_mov_b32 exec_hi, s29
    global_load_lds_dwordx4 v248, s[4:5] offset:0
    s_addk_i32 m0, 16
    s_nop 0
    global_load_lds_dwordx4 v248, s[4:5] offset:896
    s_addk_i32 m0, 16
    s_nop 0
    global_load_lds_dwordx4 v248, s[4:5] offset:1792
    s_addk_i32 m0, 16
    s_nop 0
    global_load_lds_dwordx4 v248, s[4:5] offset:2688
    s_addk_i32 m0, 3600
    s_nop 0
    global_load_lds_dwordx4 v249, s[4:5] offset:0
    s_addk_i32 m0, 16
    s_nop 0
    global_load_lds_dwordx4 v249, s[4:5] offset:896
    s_addk_i32 m0, 16
    s_nop 0
    global_load_lds_dwordx4 v249, s[4:5] offset:1792
    s_addk_i32 m0, 16
    s_nop 0
    global_load_lds_dwordx4 v249, s[4:5] offset:2688
    s_mov_b32 exec_hi, -1
    s_waitcnt vmcnt(24)
L_join:
    v_readfirstlane_b32 s36, v4
    s_barrier
    ds_read_b128 a[200:203], v215 offset:0
    ds_read_b128 a[204:207], v215 offset:32
    ds_read_b128 a[208:211], v215 offset:64
    ds_read_b128 a[212:215], v215 offset:96
    ds_read_b128 a[216:219], v215 offset:128
    ds_read_b128 a[220:223], v215 offset:160
    ds_read_b128 a[224:227], v215 offset:192
    ds_read_b128 a[228:231], v215 offset:224
    ds_read_b128 a[232:235], v215 offset:256
    ds_read_b128 a[236:239], v215 offset:288
    ds_read_b128 a[240:243], v215 offset:320
    ds_read_b128 a[244:247], v215 offset:352
    s_add_u32 s36, s36, 1
    s_mov_b32 s37, s36
    v_mov_b32 v4, s36
    s_mov_b32 m0, s62
    s_mov_b32 exec_hi, s29
    global_load_lds_dwordx4 v223, s[6:7] offset:0
    s_mov_b32 exec_hi, -1
    s_addk_i32 m0, -896
    s_waitcnt lgkmcnt(11)
    v_mfma_f32_32x32x16_bf16 v[72:87], a[200:203], v[128:131], 0
    s_add_u32 s34, s34, s33
    s_mul_i32 s31, s34, 56
    s_add_u32 s31, s31, 58368
    v_add_u32 v217, s31, v230
    ds_read_b128 a[248:251], v215 offset:384
    s_waitcnt lgkmcnt(11)
    v_mfma_f32_32x32x16_bf16 v[72:87], a[204:207], v[132:135], v[72:87]
    s_mov_b32 exec_hi, s29
    global_load_lds_dwordx4 v223, s[6:7] offset:1792
    s_mov_b32 exec_hi, -1
    ds_read_b128 a[252:255], v215 offset:416
    s_waitcnt lgkmcnt(11)
    v_mfma_f32_32x32x16_bf16 v[72:87], a[208:211], v[136:139], v[72:87]
    s_cmp_eq_u32 s25, 3
    s_cselect_b32 s68, -344064, s38
    s_addk_i32 m0, 896
    v_add_u32 v223, s68, v223
    s_ashr_i32 s68, s68, 3
    s_add_u32 m0, m0, s68
    s_mul_i32 s31, s22, 2176
    s_add_u32 s31, s31, 137728
    v_lshl_add_u32 v230, v212, 4, s31
    ds_read_b128 a[200:203], v215 offset:448
    s_waitcnt lgkmcnt(11)
    v_mfma_f32_32x32x16_bf16 v[72:87], a[212:215], v[140:143], v[72:87]
    v_add_u32 v201, v230, v1
    s_movk_i32 s39, 384
    s_mul_i32 s34, s22, 24576
    s_add_u32 s34, s34, 65536
    ds_read_b128 a[204:207], v215 offset:480
    s_waitcnt lgkmcnt(11)
    v_mfma_f32_32x32x16_bf16 v[72:87], a[216:219], v[144:147], v[72:87]
    s_mov_b32 exec_hi, s29
    global_load_lds_dwordx4 v223, s[6:7] offset:0
    s_mov_b32 exec_hi, -1
    ds_read_b128 a[208:211], v215 offset:512
    s_waitcnt lgkmcnt(11)
    v_mfma_f32_32x32x16_bf16 v[72:87], a[220:223], v[148:151], v[72:87]
    s_cmp_ge_u32 s22, 2
    s_cbranch_scc1 L_nofl1
    s_waitcnt vmcnt(3)
    s_mov_b64 exec, 1
    global_store_dword v5, v4, s[20:21] offset:0 sc1
    s_mov_b64 exec, -1
L_nofl1:
    s_addk_i32 m0, -896
    v_mov_b32 v224, s34
    ds_read_b128 a[212:215], v215 offset:544
    s_waitcnt lgkmcnt(11)
    v_mfma_f32_32x32x16_bf16 v[72:87], a[224:227], v[152:155], v[72:87]
    v_lshl_add_u32 v230, s23, 3, v0
    v_and_b32 v230, 63, v230
    v_mad_u32_u24 v224, v230, s39, v224
    ds_read_b128 a[216:219], v215 offset:576
    s_waitcnt lgkmcnt(11)
    v_mfma_f32_32x32x16_bf16 v[72:87], a[228:231], v[156:159], v[72:87]
    s_mov_b32 exec_hi, s29
    global_load_lds_dwordx4 v223, s[6:7] offset:1792
    s_mov_b32 exec_hi, -1
    ds_read_b128 a[220:223], v215 offset:608
    s_waitcnt lgkmcnt(11)
    v_mfma_f32_32x32x16_bf16 v[72:87], a[232:235], v[160:163], v[72:87]
    s_addk_i32 m0, 8064
    v_add_u32 v223, s38, v223
    s_lshl_b32 s35, s22, 16
    s_add_u32 s35, s35, 266240
    ds_read_b128 a[224:227], v215 offset:640
    s_waitcnt lgkmcnt(11)
    v_mfma_f32_32x32x16_bf16 v[72:87], a[236:239], v[164:167], v[72:87]
    s_add_u32 s56, s20, s35
    s_addc_u32 s57, s21, 0
    s_lshl_b32 s64, s23, 13
    ds_read_b128 a[228:231], v215 offset:672
    s_waitcnt lgkmcnt(11)
    v_mfma_f32_32x32x16_bf16 v[72:87], a[240:243], v[168:171], v[72:87]
    s_mov_b32 exec_hi, s29
    global_load_lds_dwordx4 v223, s[6:7] offset:0
    s_mov_b32 exec_hi, -1
    ds_read_b128 a[232:235], v215 offset:704
    s_waitcnt lgkmcnt(11)
    v_mfma_f32_32x32x16_bf16 v[72:87], a[244:247], v[172:175], v[72:87]
    s_addk_i32 m0, -896
    s_add_u32 s40, s56, s64
    s_addc_u32 s41, s57, 0
    ds_read_b128 a[236:239], v215 offset:736
    s_waitcnt lgkmcnt(11)
    v_mfma_f32_32x32x16_bf16 v[72:87], a[248:251], v[176:179], v[72:87]
    v_bfe_u32 v230, v0, 3, 1
    v_lshl_add_u32 v230, v212, 3, v230
    v_and_b32 v231, 0x70, v1
    ds_read_b128 a[240:243], v215 offset:768
    s_waitcnt lgkmcnt(11)
    v_mfma_f32_32x32x16_bf16 v[72:87], a[252:255], v[180:183], v[72:87]
    s_mov_b32 exec_hi, s29
    global_load_lds_dwordx4 v223, s[6:7] offset:1792
    s_mov_b32 exec_hi, -1
    ds_read_b128 a[244:247], v215 offset:800
    s_waitcnt lgkmcnt(11)
    v_mfma_f32_32x32x16_bf16 v[88:103], a[200:203], v[128:131], 0
    s_cmp_eq_u32 s25, 2
    s_cselect_b32 s68, -344064, s38
    s_addk_i32 m0, 896
    v_add_u32 v223, s68, v223
    s_ashr_i32 s68, s68, 3
    s_add_u32 m0, m0, s68
    v_lshl_add_u32 v230, v230, 13, v231
    ds_read_b128 a[248:251], v215 offset:832
    s_waitcnt lgkmcnt(11)
    v_mfma_f32_32x32x16_bf16 v[88:103], a[204:207], v[132:135], v[88:103]
    s_lshl_b32 s31, s22, 5
    s_add_u32 s31, s31, s25
    s_lshl_b32 s31, s31, 7
    ds_read_b128 a[252:255], v215 offset:864
    s_waitcnt lgkmcnt(11)
    v_mfma_f32_32x32x16_bf16 v[88:103], a[208:211], v[136:139], v[88:103]
    s_mov_b32 exec_hi, s29
    global_load_lds_dwordx4 v223, s[6:7] offset:0
    s_mov_b32 exec_hi, -1
    s_waitcnt lgkmcnt(10)
    v_mfma_f32_32x32x16_bf16 v[88:103], a[212:215], v[140:143], v[88:103]
    s_addk_i32 m0, -896
    s_add_u32 s31, s31, s27
    s_lshl_b32 s31, s31, 7
    s_add_u32 s31, s31, 3145728
    s_waitcnt lgkmcnt(9)
    v_mfma_f32_32x32x16_bf16 v[88:103], a[216:219], v[144:147], v[88:103]
    v_add_u32 v216, s31, v230
    v_add_u32 v202, 0x40000, v216
    s_lshl_b32 s31, s22, 11
    s_add_u32 s31, s31, 150528
    v_add_u32 v219, s31, v1
    s_waitcnt lgkmcnt(8)
    v_mfma_f32_32x32x16_bf16 v[88:103], a[220:223], v[148:151], v[88:103]
    s_mov_b32 exec_hi, s29
    global_load_lds_dwordx4 v223, s[6:7] offset:1792
    s_mov_b32 exec_hi, -1
    s_waitcnt lgkmcnt(7)
    v_mfma_f32_32x32x16_bf16 v[88:103], a[224:227], v[152:155], v[88:103]
    s_addk_i32 m0, 8064
    v_add_u32 v223, s38, v223
    s_add_u32 s31, s22, 1
    s_and_b32 s31, s31, 3
    s_waitcnt lgkmcnt(6)
    v_mfma_f32_32x32x16_bf16 v[88:103], a[228:231], v[156:159], v[88:103]
    s_lshl_b32 s34, s31, 11
    s_add_u32 s34, s34, 150528
    v_add_u32 v220, s34, v1
    s_waitcnt lgkmcnt(5)
    v_mfma_f32_32x32x16_bf16 v[88:103], a[232:235], v[160:163], v[88:103]
    s_mov_b32 exec_hi, s29
    global_load_lds_dwordx4 v223, s[6:7] offset:0
    s_mov_b32 exec_hi, -1
    s_waitcnt lgkmcnt(4)
    v_mfma_f32_32x32x16_bf16 v[88:103], a[236:239], v[164:167], v[88:103]
    s_addk_i32 m0, -896
    s_add_u32 s31, s22, 2
    s_and_b32 s31, s31, 3
    s_waitcnt lgkmcnt(3)
    v_mfma_f32_32x32x16_bf16 v[88:103], a[240:243], v[168:171], v[88:103]
    s_lshl_b32 s34, s31, 11
    s_add_u32 s34, s34, 150528
    v_add_u32 v221, s34, v1
    s_waitcnt lgkmcnt(2)
    v_mfma_f32_32x32x16_bf16 v[88:103], a[244:247], v[172:175], v[88:103]
    s_mov_b32 exec_hi, s29
    global_load_lds_dwordx4 v223, s[6:7] offset:1792
    s_mov_b32 exec_hi, -1
    s_waitcnt lgkmcnt(1)
    v_mfma_f32_32x32x16_bf16 v[88:103], a[248:251], v[176:179], v[88:103]
    s_cmp_eq_u32 s25, 1
    s_cselect_b32 s68, -344064, s38
    s_addk_i32 m0, 896
    v_add_u32 v223, s68, v223
    s_ashr_i32 s68, s68, 3
    s_add_u32 m0, m0, s68
    s_add_u32 s31, s22, 3
    s_and_b32 s31, s31, 3
    s_waitcnt lgkmcnt(0)
    v_mfma_f32_32x32x16_bf16 v[88:103], a[252:255], v[180:183], v[88:103]
    s_lshl_b32 s34, s31, 11
    s_add_u32 s34, s34, 150528
    v_add_u32 v222, s34, v1
    s_mov_b32 exec_hi, s29
    global_load_lds_dwordx4 v223, s[6:7] offset:0
    s_mov_b32 exec_hi, -1
    s_waitcnt vmcnt(9)
    s_barrier
    ds_read_b128 a[72:75], v218 offset:0
    ds_read_b64_tr_b16 a[184:185], v217 offset:0
    ds_read_b64_tr_b16 a[186:187], v217 offset:112
    ds_read_b128 a[76:79], v218 offset:32
    ds_read_b64_tr_b16 a[188:189], v217 offset:1792
    ds_read_b64_tr_b16 a[190:191], v217 offset:1904
    ds_read_b128 a[80:83], v218 offset:64
    ds_read_b64_tr_b16 a[192:193], v217 offset:3584
    ds_read_b64_tr_b16 a[194:195], v217 offset:3696
    ds_read_b128 a[84:87], v218 offset:96
    ds_read_b64_tr_b16 a[196:197], v217 offset:5376
    ds_read_b64_tr_b16 a[198:199], v217 offset:5488
    v_pk_fma_f32 v[72:73], v[88:89], v[116:117], v[72:73] op_sel_hi:[1,0,1]
    v_pk_fma_f32 v[74:75], v[90:91], v[116:117], v[74:75] op_sel_hi:[1,0,1]
    v_pk_fma_f32 v[76:77], v[92:93], v[116:117], v[76:77] op_sel_hi:[1,0,1]
    v_pk_fma_f32 v[78:79], v[94:95], v[116:117], v[78:79] op_sel_hi:[1,0,1]
    v_pk_fma_f32 v[80:81], v[96:97], v[116:117], v[80:81] op_sel_hi:[1,0,1]
    v_pk_fma_f32 v[82:83], v[98:99], v[116:117], v[82:83] op_sel_hi:[1,0,1]
    v_pk_fma_f32 v[84:85], v[100:101], v[116:117], v[84:85] op_sel_hi:[1,0,1]
    v_pk_fma_f32 v[86:87], v[102:103], v[116:117], v[86:87] op_sel_hi:[1,0,1]
    v_cvt_pk_bf16_f32 v104, v72, v73
    v_cvt_pk_bf16_f32 v105, v74, v75
    v_cvt_pk_bf16_f32 v106, v76, v77
    v_cvt_pk_bf16_f32 v107, v78, v79
    v_cvt_pk_bf16_f32 v108, v80, v81
    v_cvt_pk_bf16_f32 v109, v82, v83
    v_cvt_pk_bf16_f32 v110, v84, v85
    v_cvt_pk_bf16_f32 v111, v86, v87
    v_mfma_f32_32x32x16_bf16 v[72:87], v[104:107], v[16:19], 0
    s_addk_i32 m0, -896
    s_mov_b32 exec_hi, s29
    global_load_lds_dwordx4 v223, s[6:7] offset:1792
    s_mov_b32 exec_hi, -1
    v_mfma_f32_32x32x16_bf16 v[88:103], v[104:107], v[20:23], 0
    v_mov_b32 v2, 0xdddddddd
    s_addk_i32 s64, 0x2000
    s_and_b32 s64, s64, 0xe000
    s_add_u32 s42, s56, s64
    s_addc_u32 s43, s57, 0
    s_lshl1_add_u32 s31, s26, s32
    s_lshl3_add_u32 s31, s31, s24
    s_lshl1_add_u32 s31, s31, s33
    v_mfma_f32_32x32x16_bf16 v[72:87], v[108:111], v[24:27], v[72:87]
    s_addk_i32 m0, 8064
    v_add_u32 v223, s38, v223
    s_mov_b32 exec_hi, s29
    global_load_lds_dwordx4 v223, s[6:7] offset:0
    s_mov_b32 exec_hi, -1
    v_mfma_f32_32x32x16_bf16 v[88:103], v[108:111], v[28:31], v[88:103]
    s_lshl_b32 s31, s31, 11
    s_add_u32 s61, s31, 1048576
    v_add_u32 v15, s61, v1
    s_addk_i32 s64, 0x2000
    s_and_b32 s64, s64, 0xe000
    s_add_u32 s44, s56, s64
    s_addc_u32 s45, s57, 0
    v_mfma_f32_32x32x16_bf16 v[16:31], v[112:115], v[112:115], 0
    s_waitcnt lgkmcnt(9)
    v_mfma_f32_32x32x16_bf16 v[184:199], a[184:187], a[72:75], 0
    s_waitcnt vmcnt(7)
    s_barrier
    s_cmp_eq_u32 s25, 3
    s_cselect_b32 s68, -6, 1
    s_mul_i32 s69, s68, 7168
    v_add_u32 v217, s69, v217
    s_cmp_eq_u32 s25, 3
    s_cselect_b32 s69, -6, 1
    v_lshl_add_u32 v218, s69, 7, v218
    ds_read_b128 a[88:91], v218 offset:0
    ds_read_b64_tr_b16 a[48:49], v217 offset:0
    ds_read_b64_tr_b16 a[50:51], v217 offset:112
    s_addk_i32 m0, -896
    s_waitcnt lgkmcnt(9)
    v_mfma_f32_32x32x16_bf16 v[184:199], a[188:191], a[76:79], v[184:199]
    ds_read_b128 a[92:95], v218 offset:32
    ds_read_b64_tr_b16 a[52:53], v217 offset:1792
    ds_read_b64_tr_b16 a[54:55], v217 offset:1904
    v_add_f32 v72, v72, v92
    v_add_f32 v73, v73, v93
    v_add_f32 v74, v74, v94
    v_add_f32 v75, v75, v95
    s_waitcnt lgkmcnt(9)
    v_mfma_f32_32x32x16_bf16 v[184:199], a[192:195], a[80:83], v[184:199]
    ds_read_b128 a[96:99], v218 offset:64
    ds_read_b64_tr_b16 a[56:57], v217 offset:3584
    ds_read_b64_tr_b16 a[58:59], v217 offset:3696
    s_mov_b64 exec, 0xffff
    global_load_dwordx2 v[226:227], v224, s[20:21] sc1
    s_mov_b64 exec, -1
    s_waitcnt lgkmcnt(9)
    v_mfma_f32_32x32x16_bf16 v[184:199], a[196:199], a[84:87], v[184:199]
    ds_read_b128 a[100:103], v218 offset:96
    ds_read_b64_tr_b16 a[60:61], v217 offset:5376
    ds_read_b64_tr_b16 a[62:63], v217 offset:5488
    s_mov_b32 exec_hi, s29
    global_load_lds_dwordx4 v223, s[6:7] offset:1792
    s_mov_b32 exec_hi, -1
    s_waitcnt lgkmcnt(9)
    v_mfma_f32_32x32x16_bf16 v[184:199], a[48:51], a[88:91], v[184:199]
    ds_read_b128 a[104:107], v218 offset:128
    ds_read_b64_tr_b16 a[64:65], v217 offset:7168
    ds_read_b64_tr_b16 a[66:67], v217 offset:7280
    s_waitcnt lgkmcnt(9)
    v_mfma_f32_32x32x16_bf16 v[184:199], a[52:55], a[92:95], v[184:199]
    ds_read_b128 a[108:111], v218 offset:160
    ds_read_b64_tr_b16 a[68:69], v217 offset:8960
    ds_read_b64_tr_b16 a[70:71], v217 offset:9072
    v_sub_f32 v76, v76, v88
    v_sub_f32 v77, v77, v89
    v_sub_f32 v78, v78, v90
    v_sub_f32 v79, v79, v91
    s_waitcnt lgkmcnt(9)
    v_mfma_f32_32x32x16_bf16 v[184:199], a[56:59], a[96:99], v[184:199]
    ds_read_b128 a[112:115], v218 offset:192
    ds_read_b64_tr_b16 a[184:185], v217 offset:10752
    ds_read_b64_tr_b16 a[186:187], v217 offset:10864
    v_cvt_pk_bf16_f32 v104, v72, v73
    v_cvt_pk_bf16_f32 v105, v74, v75
    v_cvt_pk_bf16_f32 v106, v76, v77
    v_cvt_pk_bf16_f32 v107, v78, v79
    s_waitcnt lgkmcnt(9)
    v_mfma_f32_32x32x16_bf16 v[184:199], a[60:63], a[100:103], v[184:199]
    ds_read_b128 a[116:119], v218 offset:224
    ds_read_b64_tr_b16 a[188:189], v217 offset:12544
    ds_read_b64_tr_b16 a[190:191], v217 offset:12656
    ds_write_b128 v200, v[104:107] offset:0
    v_add_f32 v80, v80, v100
    v_add_f32 v81, v81, v101
    v_add_f32 v82, v82, v102
    s_waitcnt lgkmcnt(10)
    v_mfma_f32_32x32x16_bf16 v[184:199], a[64:67], a[104:107], v[184:199]
    s_waitcnt vmcnt(5)
    s_barrier
    s_cmp_eq_u32 s25, 2
    s_cselect_b32 s68, -5, 2
    s_mul_i32 s69, s68, 7168
    v_add_u32 v217, s69, v217
    s_cmp_eq_u32 s25, 2
    s_cselect_b32 s69, -5, 2
    v_lshl_add_u32 v218, s69, 7, v218
    ds_read_b128 a[120:123], v218 offset:0
    ds_read_b64_tr_b16 a[192:193], v217 offset:0
    ds_read_b64_tr_b16 a[194:195], v217 offset:112
    v_add_f32 v83, v83, v103
    v_sub_f32 v84, v84, v96
    v_sub_f32 v85, v85, v97
    v_sub_f32 v86, v86, v98
    s_waitcnt lgkmcnt(10)
    v_mfma_f32_32x32x16_bf16 v[184:199], a[68:71], a[108:111], v[184:199]
    ds_read_b128 a[124:127], v218 offset:32
    ds_read_b64_tr_b16 a[196:197], v217 offset:1792
    ds_read_b64_tr_b16 a[198:199], v217 offset:1904
    v_sub_f32 v87, v87, v99
    v_cvt_pk_bf16_f32 v108, v80, v81
    v_cvt_pk_bf16_f32 v109, v82, v83
    v_cvt_pk_bf16_f32 v110, v84, v85
    s_waitcnt lgkmcnt(10)
    v_mfma_f32_32x32x16_bf16 v[184:199], a[184:187], a[112:115], v[184:199]
    ds_read_b128 a[128:131], v218 offset:64
    ds_read_b64_tr_b16 a[48:49], v217 offset:3584
    ds_read_b64_tr_b16 a[50:51], v217 offset:3696
    v_cvt_pk_bf16_f32 v111, v86, v87
    ds_write_b128 v200, v[108:111] offset:32
    s_waitcnt lgkmcnt(11)
    v_mfma_f32_32x32x16_bf16 v[184:199], a[188:191], a[116:119], v[184:199]
    ds_read_b128 a[132:135], v218 offset:96
    ds_read_b64_tr_b16 a[52:53], v217 offset:5376
    ds_read_b64_tr_b16 a[54:55], v217 offset:5488
    s_addk_i32 s64, 0x2000
    s_and_b32 s64, s64, 0xe000
    s_waitcnt lgkmcnt(10)
    v_mfma_f32_32x32x16_bf16 v[184:199], a[192:195], a[120:123], v[184:199]
    ds_read_b128 a[136:139], v218 offset:128
    ds_read_b64_tr_b16 a[56:57], v217 offset:7168
    ds_read_b64_tr_b16 a[58:59], v217 offset:7280
    s_add_u32 s46, s56, s64
    s_addc_u32 s47, s57, 0
    s_waitcnt lgkmcnt(10)
    v_mfma_f32_32x32x16_bf16 v[184:199], a[196:199], a[124:127], v[184:199]
    ds_read_b128 a[140:143], v218 offset:160
    ds_read_b64_tr_b16 a[60:61], v217 offset:8960
    ds_read_b64_tr_b16 a[62:63], v217 offset:9072
    s_waitcnt vmcnt(1)
    v_cmp_ne_u64 vcc, s[36:37], v[226:227]
    s_addk_i32 s64, 0x2000
    s_and_b32 s64, s64, 0xe000
    s_waitcnt lgkmcnt(10)
    v_mfma_f32_32x32x16_bf16 v[184:199], a[48:51], a[128:131], v[184:199]
    ds_read_b128 a[144:147], v218 offset:192
    ds_read_b64_tr_b16 a[64:65], v217 offset:10752
    ds_read_b64_tr_b16 a[66:67], v217 offset:10864
    s_and_b32 vcc_lo, vcc_lo, 0xffff
    s_cbranch_scc1 L_p1
L_p1r:
    global_load_dwordx4 v[128:131], v1, s[40:41] offset:-4096 sc1
    s_waitcnt lgkmcnt(9)
    v_mfma_f32_32x32x16_bf16 v[184:199], a[52:55], a[132:135], v[184:199]
    ds_read_b128 a[148:151], v218 offset:224
    ds_read_b64_tr_b16 a[68:69], v217 offset:12544
    ds_read_b64_tr_b16 a[70:71], v217 offset:12656
    global_load_dwordx4 v[132:135], v1, s[40:41] offset:-3072 sc1
    s_waitcnt lgkmcnt(9)
    v_mfma_f32_32x32x16_bf16 v[184:199], a[56:59], a[136:139], v[184:199]
    s_waitcnt vmcnt(2)
    s_barrier
    ds_read_b128 a[216:219], v201 offset:0
    ds_read_b128 a[220:223], v201 offset:1088
    s_cmp_eq_u32 s25, 1
    s_cselect_b32 s68, -5, 2
    s_mul_i32 s69, s68, 7168
    v_add_u32 v217, s69, v217
    s_cmp_eq_u32 s25, 1
    s_cselect_b32 s69, -5, 2
    v_lshl_add_u32 v218, s69, 7, v218
    ds_read_b128 a[152:155], v218 offset:0
    ds_read_b64_tr_b16 a[184:185], v217 offset:0
    ds_read_b64_tr_b16 a[186:187], v217 offset:112
    global_load_dwordx4 v[136:139], v1, s[40:41] offset:-2048 sc1
    s_waitcnt lgkmcnt(11)
    v_mfma_f32_32x32x16_bf16 v[184:199], a[60:63], a[140:143], v[184:199]
    ds_read_b128 a[156:159], v218 offset:32
    ds_read_b64_tr_b16 a[188:189], v217 offset:1792
    ds_read_b64_tr_b16 a[190:191], v217 offset:1904
    global_load_dwordx4 v[140:143], v1, s[40:41] offset:-1024 sc1
    s_waitcnt lgkmcnt(11)
    v_mfma_f32_32x32x16_bf16 v[184:199], a[64:67], a[144:147], v[184:199]
    ds_read_b128 a[160:163], v218 offset:64
    ds_read_b64_tr_b16 a[192:193], v217 offset:3584
    ds_read_b64_tr_b16 a[194:195], v217 offset:3696
    global_load_dwordx4 v[144:147], v1, s[40:41] offset:0 sc1
    s_waitcnt lgkmcnt(11)
    v_mfma_f32_32x32x16_bf16 v[184:199], a[68:71], a[148:151], v[184:199]
    ds_read_b128 a[164:167], v218 offset:96
    ds_read_b64_tr_b16 a[196:197], v217 offset:5376
    ds_read_b64_tr_b16 a[198:199], v217 offset:5488
    global_load_dwordx4 v[148:151], v1, s[40:41] offset:1024 sc1
    s_waitcnt lgkmcnt(9)
    v_mfma_f32_32x32x16_bf16 v[184:199], a[184:187], a[152:155], v[184:199]
    ds_read_b128 a[168:171], v218 offset:128
    ds_read_b64_tr_b16 a[48:49], v217 offset:7168
    ds_read_b64_tr_b16 a[50:51], v217 offset:7280
    global_load_dwordx4 v[152:155], v1, s[40:41] offset:2048 sc1
    s_waitcnt lgkmcnt(9)
    v_mfma_f32_32x32x16_bf16 v[184:199], a[188:191], a[156:159], v[184:199]
    ds_read_b128 a[172:175], v218 offset:160
    ds_read_b64_tr_b16 a[52:53], v217 offset:8960
    ds_read_b64_tr_b16 a[54:55], v217 offset:9072
    global_load_dwordx4 v[156:159], v1, s[40:41] offset:3072 sc1
    s_waitcnt lgkmcnt(9)
    v_mfma_f32_32x32x16_bf16 v[184:199], a[192:195], a[160:163], v[184:199]
    ds_read_b128 a[176:179], v218 offset:192
    ds_read_b64_tr_b16 a[56:57], v217 offset:10752
    ds_read_b64_tr_b16 a[58:59], v217 offset:10864
    global_load_dwordx2 v[226:227], v224, s[20:21] sc1
    s_waitcnt lgkmcnt(9)
    v_mfma_f32_32x32x16_bf16 v[184:199], a[196:199], a[164:167], v[184:199]
    ds_read_b128 a[180:183], v218 offset:224
    ds_read_b64_tr_b16 a[60:61], v217 offset:12544
    ds_read_b64_tr_b16 a[62:63], v217 offset:12656
    s_add_u32 s48, s56, s64
    s_addc_u32 s49, s57, 0
    s_waitcnt lgkmcnt(9)
    v_mfma_f32_32x32x16_bf16 v[184:199], a[48:51], a[168:171], v[184:199]
    s_addk_i32 s64, 0x2000
    s_and_b32 s64, s64, 0xe000
    s_add_u32 s50, s56, s64
    s_addc_u32 s51, s57, 0
    s_waitcnt lgkmcnt(6)
    v_mfma_f32_32x32x16_bf16 v[184:199], a[52:55], a[172:175], v[184:199]
    s_addk_i32 s64, 0x2000
    s_and_b32 s64, s64, 0xe000
    s_add_u32 s52, s56, s64
    s_addc_u32 s53, s57, 0
    s_waitcnt lgkmcnt(3)
    v_mfma_f32_32x32x16_bf16 v[184:199], a[56:59], a[176:179], v[184:199]
    s_addk_i32 s64, 0x2000
    s_and_b32 s64, s64, 0xe000
    s_add_u32 s54, s56, s64
    s_addc_u32 s55, s57, 0
    s_waitcnt lgkmcnt(0)
    v_mfma_f32_32x32x16_bf16 v[184:199], a[60:63], a[180:183], v[184:199]
    s_add_u32 s31, s22, 1
    s_and_b32 s31, s31, 3
    s_mul_i32 s34, s31, 12288
    s_add_u32 s34, s34, 8192
    v_add_u32 v13, s34, v1
    s_add_u32 s31, s22, 2
    s_and_b32 s31, s31, 3
    s_mul_i32 s34, s31, 12288
    s_add_u32 s34, s34, 4096
    v_add_u32 v12, s34, v1
    s_add_u32 s31, s22, 3
    s_and_b32 s31, s31, 3
    v_cvt_pk_bf16_f32 v32, v184, v185
    v_cvt_pk_bf16_f32 v33, v186, v187
    v_cvt_pk_bf16_f32 v34, v188, v189
    v_cvt_pk_bf16_f32 v35, v190, v191
    v_cvt_pk_bf16_f32 v36, v192, v193
    v_cvt_pk_bf16_f32 v37, v194, v195
    v_cvt_pk_bf16_f32 v38, v196, v197
    v_cvt_pk_bf16_f32 v39, v198, v199
    s_mov_b32 exec_lo, 0
    v_mov_b32 v38, 0xc1f0
    v_mov_b32 v39, 0
    s_mov_b32 exec_lo, -1
    ds_write_b128 v219, v[32:35]
    ds_write_b128 v219, v[36:39] offset:1024
    .p2align 3
    s_waitcnt vmcnt(8)
    v_mfma_f32_32x32x16_bf16 v[72:87], v[128:131], v[32:35], 0
    s_waitcnt vmcnt(7)
    v_mfma_f32_32x32x16_bf16 v[72:87], v[132:135], v[36:39], v[72:87]
    s_waitcnt vmcnt(4)
    v_mfma_f32_32x32x16_bf16 v[88:103], v[144:147], v[32:35], 0
    global_load_dwordx4 v[160:163], v1, s[42:43] offset:-4096 sc1
    s_nop 7
    s_nop 0
    v_exp_f32 v72, v72
    v_exp_f32 v73, v73
    v_exp_f32 v74, v74
    v_exp_f32 v75, v75
    s_waitcnt vmcnt(4)
    v_mfma_f32_32x32x16_bf16 v[88:103], v[148:151], v[36:39], v[88:103]
    s_waitcnt lgkmcnt(0)
    s_barrier
    ds_read_b128 a[48:51], v220 offset:0
    ds_read_b128 a[52:55], v220 offset:1024
    v_exp_f32 v76, v76
    v_exp_f32 v77, v77
    v_exp_f32 v78, v78
    v_exp_f32 v79, v79
    ds_read_b128 a[56:59], v221 offset:0
    ds_read_b128 a[60:63], v221 offset:1024
    v_exp_f32 v80, v80
    v_exp_f32 v81, v81
    v_exp_f32 v82, v82
    v_exp_f32 v83, v83
    ds_read_b128 a[64:67], v222 offset:0
    ds_read_b128 a[68:71], v222 offset:1024
    v_exp_f32 v84, v84
    v_exp_f32 v85, v85
    v_exp_f32 v86, v86
    v_exp_f32 v87, v87
    s_waitcnt lgkmcnt(4)
    v_mfma_f32_32x32x16_bf16 v[104:119], v[128:131], a[48:51], 0
    global_load_dwordx4 v[164:167], v1, s[42:43] offset:-3072 sc1
    v_exp_f32 v88, v88
    v_exp_f32 v89, v89
    v_exp_f32 v90, v90
    v_exp_f32 v91, v91
    v_mfma_f32_32x32x16_bf16 v[104:119], v[132:135], a[52:55], v[104:119]
    global_load_dwordx4 v[168:171], v1, s[42:43] offset:-2048 sc1
    v_exp_f32 v92, v92
    v_exp_f32 v93, v93
    v_exp_f32 v94, v94
    v_exp_f32 v95, v95
    v_smfmac_f32_32x32x32_bf16 v[16:31], v[136:139], v[72:79], v2
    s_mul_i32 s34, s31, 12288
    s_add_u32 s34, s34, 0
    v_exp_f32 v96, v96
    v_exp_f32 v97, v97
    v_exp_f32 v98, v98
    v_exp_f32 v99, v99
    v_smfmac_f32_32x32x32_bf16 v[16:31], v[140:143], v[80:87], v2
    v_add_u32 v11, s34, v1
    v_exp_f32 v100, v100
    v_exp_f32 v101, v101
    v_exp_f32 v102, v102
    v_exp_f32 v103, v103
    s_waitcnt lgkmcnt(2)
    v_mfma_f32_32x32x16_bf16 v[72:87], v[128:131], a[56:59], 0
    global_load_dwordx4 v[172:175], v1, s[42:43] offset:-1024 sc1
    v_exp_f32 v104, v104
    v_exp_f32 v105, v105
    v_exp_f32 v106, v106
    v_exp_f32 v107, v107
    v_mfma_f32_32x32x16_bf16 v[72:87], v[132:135], a[60:63], v[72:87]
    s_mov_b32 s67, 0
    v_exp_f32 v108, v108
    v_exp_f32 v109, v109
    v_exp_f32 v110, v110
    v_exp_f32 v111, v111
    s_waitcnt vmcnt(6)
    v_smfmac_f32_32x32x32_bf16 v[16:31], v[152:155], v[88:95], v2
    s_lshr_b32 s35, s24, 1
    s_and_b32 s56, s24, 1
    v_exp_f32 v112, v112
    v_exp_f32 v113, v113
    v_exp_f32 v114, v114
    v_exp_f32 v115, v115
    s_waitcnt vmcnt(5)
    v_smfmac_f32_32x32x32_bf16 v[16:31], v[156:159], v[96:103], v2
    s_cmp_eq_u32 s35, 3
    s_cselect_b32 s31, 1, 3
    v_add3_u32 v230, v212, s22, 1
    v_exp_f32 v116, v116
    v_exp_f32 v117, v117
    v_exp_f32 v118, v118
    v_exp_f32 v119, v119
    s_waitcnt lgkmcnt(0)
    v_mfma_f32_32x32x16_bf16 v[88:103], v[128:131], a[64:67], 0
    global_load_dwordx4 v[176:179], v1, s[42:43] offset:0 sc1
    v_exp_f32 v72, v72
    v_exp_f32 v73, v73
    v_exp_f32 v74, v74
    v_exp_f32 v75, v75
    v_mfma_f32_32x32x16_bf16 v[88:103], v[132:135], a[68:71], v[88:103]
    global_load_dwordx4 v[180:183], v1, s[42:43] offset:1024 sc1
    v_exp_f32 v76, v76
    v_exp_f32 v77, v77
    v_exp_f32 v78, v78
    v_exp_f32 v79, v79
    v_smfmac_f32_32x32x32_bf16 a[0:15], v[136:139], v[104:111], v2
    v_and_b32 v230, s31, v230
    v_lshl_add_u32 v230, v230, 2, v208
    v_exp_f32 v80, v80
    v_exp_f32 v81, v81
    v_exp_f32 v82, v82
    v_exp_f32 v83, v83
    v_smfmac_f32_32x32x32_bf16 a[0:15], v[140:143], v[112:119], v2
    s_barrier
    v_exp_f32 v84, v84
    v_exp_f32 v85, v85
    v_exp_f32 v86, v86
    v_exp_f32 v87, v87
    v_mfma_f32_32x32x16_bf16 v[104:119], v[144:147], a[48:51], 0
    global_load_dwordx4 v[184:187], v1, s[42:43] offset:2048 sc1
    v_exp_f32 v88, v88
    v_exp_f32 v89, v89
    v_exp_f32 v90, v90
    v_exp_f32 v91, v91
    v_mfma_f32_32x32x16_bf16 v[104:119], v[148:151], a[52:55], v[104:119]
    v_mul_u32_u24 v231, 56, v209
    v_exp_f32 v92, v92
    v_exp_f32 v93, v93
    v_exp_f32 v94, v94
    v_exp_f32 v95, v95
    v_smfmac_f32_32x32x32_bf16 a[16:31], v[136:139], v[72:79], v2
    s_waitcnt vmcnt(7)
    v_cmp_ne_u64 vcc, s[36:37], v[226:227]
    v_exp_f32 v96, v96
    v_exp_f32 v97, v97
    v_exp_f32 v98, v98
    v_exp_f32 v99, v99
    v_smfmac_f32_32x32x32_bf16 a[16:31], v[140:143], v[80:87], v2
    s_cbranch_vccnz L_pb
L_pbr:
    v_exp_f32 v100, v100
    v_exp_f32 v101, v101
    v_exp_f32 v102, v102
    v_exp_f32 v103, v103
    v_mfma_f32_32x32x16_bf16 v[72:87], v[144:147], a[56:59], 0
    global_load_dwordx4 v[188:191], v1, s[42:43] offset:3072 sc1
    v_exp_f32 v104, v104
    v_exp_f32 v105, v105
    v_exp_f32 v106, v106
    v_exp_f32 v107, v107
    v_mfma_f32_32x32x16_bf16 v[72:87], v[148:151], a[60:63], v[72:87]
    global_load_dwordx4 a[72:75], v1, s[44:45] offset:-4096 sc1
    v_exp_f32 v108, v108
    v_exp_f32 v109, v109
    v_exp_f32 v110, v110
    v_exp_f32 v111, v111
    v_smfmac_f32_32x32x32_bf16 a[32:47], v[136:139], v[88:95], v2
    s_mul_i32 s34, s22, 6272
    s_lshl4_add_u32 s34, s35, s34
    v_exp_f32 v112, v112
    v_exp_f32 v113, v113
    v_exp_f32 v114, v114
    v_exp_f32 v115, v115
    v_smfmac_f32_32x32x32_bf16 a[32:47], v[140:143], v[96:103], v2
    v_add3_u32 v230, v230, v231, s34
    v_exp_f32 v116, v116
    v_exp_f32 v117, v117
    v_exp_f32 v118, v118
    v_exp_f32 v119, v119
    v_mfma_f32_32x32x16_bf16 v[88:103], v[144:147], a[64:67], 0
    global_load_dwordx4 a[76:79], v1, s[44:45] offset:-3072 sc1
    v_exp_f32 v72, v72
    v_exp_f32 v73, v73
    v_exp_f32 v74, v74
    v_exp_f32 v75, v75
    v_mfma_f32_32x32x16_bf16 v[88:103], v[148:151], a[68:71], v[88:103]
    v_lshlrev_b32 v3, 4, v230
    v_exp_f32 v76, v76
    v_exp_f32 v77, v77
    v_exp_f32 v78, v78
    v_exp_f32 v79, v79
    v_smfmac_f32_32x32x32_bf16 a[0:15], v[152:155], v[104:111], v2
    s_sub_u32 s31, 3, s35
    s_lshl_b32 s31, s31, 6
    v_exp_f32 v80, v80
    v_exp_f32 v81, v81
    v_exp_f32 v82, v82
    v_exp_f32 v83, v83
    v_smfmac_f32_32x32x32_bf16 a[0:15], v[156:159], v[112:119], v2
    s_waitcnt vmcnt(6)
    v_exp_f32 v84, v84
    v_exp_f32 v85, v85
    v_exp_f32 v86, v86
    v_exp_f32 v87, v87
    v_mfma_f32_32x32x16_bf16 v[104:119], v[160:163], a[48:51], 0
    global_load_dwordx4 a[80:83], v1, s[44:45] offset:-2048 sc1
    v_exp_f32 v88, v88
    v_exp_f32 v89, v89
    v_exp_f32 v90, v90
    v_exp_f32 v91, v91
    v_mfma_f32_32x32x16_bf16 v[104:119], v[164:167], a[52:55], v[104:119]
    global_load_dwordx4 a[84:87], v1, s[44:45] offset:-1024 sc1
    v_exp_f32 v92, v92
    v_exp_f32 v93, v93
    v_exp_f32 v94, v94
    v_exp_f32 v95, v95
    v_smfmac_f32_32x32x32_bf16 a[16:31], v[152:155], v[72:79], v2
    v_mad_u32_u24 v230, v210, s31, v211
    s_lshl2_add_u32 s34, s35, s22
    v_exp_f32 v96, v96
    v_exp_f32 v97, v97
    v_exp_f32 v98, v98
    v_exp_f32 v99, v99
    v_smfmac_f32_32x32x32_bf16 a[16:31], v[156:159], v[80:87], v2
    s_mul_i32 s34, s34, 6144
    v_exp_f32 v100, v100
    v_exp_f32 v101, v101
    v_exp_f32 v102, v102
    v_exp_f32 v103, v103
    v_mfma_f32_32x32x16_bf16 v[72:87], v[160:163], a[56:59], 0
    global_load_dwordx4 a[88:91], v1, s[44:45] offset:0 sc1
    v_exp_f32 v104, v104
    v_exp_f32 v105, v105
    v_exp_f32 v106, v106
    v_exp_f32 v107, v107
    v_mfma_f32_32x32x16_bf16 v[72:87], v[164:167], a[60:63], v[72:87]
    s_lshr_b32 s31, s23, 1
    v_exp_f32 v108, v108
    v_exp_f32 v109, v109
    v_exp_f32 v110, v110
    v_exp_f32 v111, v111
    v_smfmac_f32_32x32x32_bf16 a[32:47], v[152:155], v[88:95], v2
    s_lshl2_add_u32 s34, s31, s34
    s_add_u32 s34, s34, 65536
    v_exp_f32 v112, v112
    v_exp_f32 v113, v113
    v_exp_f32 v114, v114
    v_exp_f32 v115, v115
    v_smfmac_f32_32x32x32_bf16 a[32:47], v[156:159], v[96:103], v2
    v_mov_b32 v7, s34
    v_exp_f32 v116, v116
    v_exp_f32 v117, v117
    v_exp_f32 v118, v118
    v_exp_f32 v119, v119
    v_mfma_f32_32x32x16_bf16 v[88:103], v[160:163], a[64:67], 0
    global_load_dwordx4 a[92:95], v1, s[44:45] offset:1024 sc1
    v_exp_f32 v72, v72
    v_exp_f32 v73, v73
    v_exp_f32 v74, v74
    v_exp_f32 v75, v75
    v_mfma_f32_32x32x16_bf16 v[88:103], v[164:167], a[68:71], v[88:103]
    global_load_dwordx4 a[96:99], v1, s[44:45] offset:2048 sc1
    v_exp_f32 v76, v76
    v_exp_f32 v77, v77
    v_exp_f32 v78, v78
    v_exp_f32 v79, v79
    v_smfmac_f32_32x32x32_bf16 a[0:15], v[168:171], v[104:111], v2
    v_mad_u32_u24 v7, v230, s39, v7
    s_mul_i32 s57, s22, 12288
    v_exp_f32 v80, v80
    v_exp_f32 v81, v81
    v_exp_f32 v82, v82
    v_exp_f32 v83, v83
    v_smfmac_f32_32x32x32_bf16 a[0:15], v[172:175], v[112:119], v2
    s_add_u32 s57, s57, 0
    v_exp_f32 v84, v84
    v_exp_f32 v85, v85
    v_exp_f32 v86, v86
    v_exp_f32 v87, v87
    v_mfma_f32_32x32x16_bf16 v[104:119], v[160:163], v[32:35], 0
    global_load_dwordx4 a[100:103], v1, s[44:45] offset:3072 sc1
    v_exp_f32 v88, v88
    v_exp_f32 v89, v89
    v_exp_f32 v90, v90
    v_exp_f32 v91, v91
    v_mfma_f32_32x32x16_bf16 v[104:119], v[164:167], v[36:39], v[104:119]
    v_add_u32 v10, s57, v1
    v_exp_f32 v92, v92
    v_exp_f32 v93, v93
    v_exp_f32 v94, v94
    v_exp_f32 v95, v95
    v_smfmac_f32_32x32x32_bf16 a[16:31], v[168:171], v[72:79], v2
    s_lshl3_add_u32 s31, s26, s24
    s_lshl2_add_u32 s31, s31, s22
    v_exp_f32 v96, v96
    v_exp_f32 v97, v97
    v_exp_f32 v98, v98
    v_exp_f32 v99, v99
    v_smfmac_f32_32x32x32_bf16 a[16:31], v[172:175], v[80:87], v2
    s_waitcnt vmcnt(8)
    v_exp_f32 v100, v100
    v_exp_f32 v101, v101
    v_exp_f32 v102, v102
    v_exp_f32 v103, v103
    v_mfma_f32_32x32x16_bf16 v[72:87], v[176:179], a[48:51], 0
    global_load_dwordx4 a[104:107], v1, s[46:47] offset:-4096 sc1
    v_exp_f32 v104, v104
    v_exp_f32 v105, v105
    v_exp_f32 v106, v106
    v_exp_f32 v107, v107
    v_mfma_f32_32x32x16_bf16 v[72:87], v[180:183], a[52:55], v[72:87]
    global_load_dwordx4 a[108:111], v1, s[46:47] offset:-3072 sc1
    v_exp_f32 v108, v108
    v_exp_f32 v109, v109
    v_exp_f32 v110, v110
    v_exp_f32 v111, v111
    v_smfmac_f32_32x32x32_bf16 a[32:47], v[168:171], v[88:95], v2
    global_store_dwordx4 v216, a[216:219], s[20:21] sc1
    v_exp_f32 v112, v112
    v_exp_f32 v113, v113
    v_exp_f32 v114, v114
    v_exp_f32 v115, v115
    v_smfmac_f32_32x32x32_bf16 a[32:47], v[172:175], v[96:103], v2
    s_lshl_b32 s31, s31, 11
    v_exp_f32 v116, v116
    v_exp_f32 v117, v117
    v_exp_f32 v118, v118
    v_exp_f32 v119, v119
    v_mfma_f32_32x32x16_bf16 v[88:103], v[176:179], a[56:59], 0
    global_load_dwordx4 a[112:115], v1, s[46:47] offset:-2048 sc1
    v_exp_f32 v72, v72
    v_exp_f32 v73, v73
    v_exp_f32 v74, v74
    v_exp_f32 v75, v75
    v_mfma_f32_32x32x16_bf16 v[88:103], v[180:183], a[60:63], v[88:103]
    s_add_u32 s59, s31, 3145728
    v_exp_f32 v76, v76
    v_exp_f32 v77, v77
    v_exp_f32 v78, v78
    v_exp_f32 v79, v79
    v_smfmac_f32_32x32x32_bf16 v[16:31], v[168:171], v[104:111], v2
    global_store_dwordx4 v202, a[220:223], s[20:21] sc1
    v_exp_f32 v80, v80
    v_exp_f32 v81, v81
    v_exp_f32 v82, v82
    v_exp_f32 v83, v83
    v_smfmac_f32_32x32x32_bf16 v[16:31], v[172:175], v[112:119], v2
    v_add_u32 v14, s59, v1
    v_exp_f32 v84, v84
    v_exp_f32 v85, v85
    v_exp_f32 v86, v86
    v_exp_f32 v87, v87
    v_mfma_f32_32x32x16_bf16 v[104:119], v[176:179], a[64:67], 0
    global_load_dwordx4 a[116:119], v1, s[46:47] offset:-1024 sc1
    v_exp_f32 v88, v88
    v_exp_f32 v89, v89
    v_exp_f32 v90, v90
    v_exp_f32 v91, v91
    v_mfma_f32_32x32x16_bf16 v[104:119], v[180:183], a[68:71], v[104:119]
    global_load_dwordx4 a[120:123], v1, s[46:47] offset:0 sc1
    v_exp_f32 v92, v92
    v_exp_f32 v93, v93
    v_exp_f32 v94, v94
    v_exp_f32 v95, v95
    v_smfmac_f32_32x32x32_bf16 a[0:15], v[184:187], v[72:79], v2
    v_lshl_add_u32 v231, v210, 2, v208
    s_mul_i32 s70, s22, 28672
    v_exp_f32 v96, v96
    v_exp_f32 v97, v97
    v_exp_f32 v98, v98
    v_exp_f32 v99, v99
    v_smfmac_f32_32x32x32_bf16 a[0:15], v[188:191], v[80:87], v2
    s_add_u32 s70, s70, 49152
    v_exp_f32 v100, v100
    v_exp_f32 v101, v101
    v_exp_f32 v102, v102
    v_exp_f32 v103, v103
    v_mfma_f32_32x32x16_bf16 v[72:87], v[176:179], v[32:35], 0
    global_load_dwordx4 a[124:127], v1, s[46:47] offset:1024 sc1
    v_exp_f32 v104, v104
    v_exp_f32 v105, v105
    v_exp_f32 v106, v106
    v_exp_f32 v107, v107
    v_mfma_f32_32x32x16_bf16 v[72:87], v[180:183], v[36:39], v[72:87]
    v_lshl_add_u32 v231, v231, 3, s70
    v_exp_f32 v108, v108
    v_exp_f32 v109, v109
    v_exp_f32 v110, v110
    v_exp_f32 v111, v111
    v_smfmac_f32_32x32x32_bf16 a[16:31], v[184:187], v[88:95], v2
    v_lshl_add_u32 v230, v207, 4, v209
    v_lshl_add_u32 v122, v230, 6, v231
    v_exp_f32 v112, v112
    v_exp_f32 v113, v113
    v_exp_f32 v114, v114
    v_exp_f32 v115, v115
    v_smfmac_f32_32x32x32_bf16 a[16:31], v[188:191], v[96:103], v2
    s_waitcnt vmcnt(12)
    v_exp_f32 v116, v116
    v_exp_f32 v117, v117
    v_exp_f32 v118, v118
    v_exp_f32 v119, v119
    v_mfma_f32_32x32x16_bf16 v[88:103], a[72:75], a[48:51], 0
    global_load_dwordx4 a[128:131], v1, s[46:47] offset:2048 sc1
    v_exp_f32 v72, v72
    v_exp_f32 v73, v73
    v_exp_f32 v74, v74
    v_exp_f32 v75, v75
    v_mfma_f32_32x32x16_bf16 v[88:103], a[76:79], a[52:55], v[88:103]
    global_load_dwordx4 a[132:135], v1, s[46:47] offset:3072 sc1
    v_exp_f32 v76, v76
    v_exp_f32 v77, v77
    v_exp_f32 v78, v78
    v_exp_f32 v79, v79
    v_smfmac_f32_32x32x32_bf16 a[32:47], v[184:187], v[104:111], v2
    v_mad_u32_u24 v232, v207, 3, v209
    v_lshl_add_u32 v231, v232, 6, v231
    v_exp_f32 v80, v80
    v_exp_f32 v81, v81
    v_exp_f32 v82, v82
    v_exp_f32 v83, v83
    v_smfmac_f32_32x32x32_bf16 a[32:47], v[188:191], v[112:119], v2
    s_movk_i32 s39, 768
    v_exp_f32 v84, v84
    v_exp_f32 v85, v85
    v_exp_f32 v86, v86
    v_exp_f32 v87, v87
    v_mfma_f32_32x32x16_bf16 v[104:119], a[72:75], a[56:59], 0
    global_load_dwordx4 a[136:139], v1, s[48:49] offset:-4096 sc1
    v_exp_f32 v88, v88
    v_exp_f32 v89, v89
    v_exp_f32 v90, v90
    v_exp_f32 v91, v91
    v_mfma_f32_32x32x16_bf16 v[104:119], a[76:79], a[60:63], v[104:119]
    v_add_u32 v230, 3, v232
    v_exp_f32 v92, v92
    v_exp_f32 v93, v93
    v_exp_f32 v94, v94
    v_exp_f32 v95, v95
    v_smfmac_f32_32x32x32_bf16 v[16:31], v[184:187], v[72:79], v2
    v_lshrrev_b32 v230, 2, v230
    v_mad_u32_u24 v123, v230, s39, v231
    v_exp_f32 v96, v96
    v_exp_f32 v97, v97
    v_exp_f32 v98, v98
    v_exp_f32 v99, v99
    v_smfmac_f32_32x32x32_bf16 v[16:31], v[188:191], v[80:87], v2
    v_add_u32 v230, 1, v232
    v_exp_f32 v100, v100
    v_exp_f32 v101, v101
    v_exp_f32 v102, v102
    v_exp_f32 v103, v103
    v_mfma_f32_32x32x16_bf16 v[72:87], a[72:75], a[64:67], 0
    global_load_dwordx4 a[140:143], v1, s[48:49] offset:-3072 sc1
    v_exp_f32 v104, v104
    v_exp_f32 v105, v105
    v_exp_f32 v106, v106
    v_exp_f32 v107, v107
    v_mfma_f32_32x32x16_bf16 v[72:87], a[76:79], a[68:71], v[72:87]
    global_load_dwordx4 a[144:147], v1, s[48:49] offset:-2048 sc1
    v_exp_f32 v108, v108
    v_exp_f32 v109, v109
    v_exp_f32 v110, v110
    v_exp_f32 v111, v111
    v_smfmac_f32_32x32x32_bf16 a[0:15], a[80:83], v[88:95], v2
    v_lshrrev_b32 v230, 2, v230
    v_mad_u32_u24 v124, v230, s39, v231
    v_exp_f32 v112, v112
    v_exp_f32 v113, v113
    v_exp_f32 v114, v114
    v_exp_f32 v115, v115
    v_smfmac_f32_32x32x32_bf16 a[0:15], a[84:87], v[96:103], v2
    s_lshl1_add_u32 s58, s26, s56
    v_exp_f32 v116, v116
    v_exp_f32 v117, v117
    v_exp_f32 v118, v118
    v_exp_f32 v119, v119
    v_mfma_f32_32x32x16_bf16 v[88:103], a[72:75], v[32:35], 0
    global_load_dwordx4 a[148:151], v1, s[48:49] offset:-1024 sc1
    v_exp_f32 v72, v72
    v_exp_f32 v73, v73
    v_exp_f32 v74, v74
    v_exp_f32 v75, v75
    v_mfma_f32_32x32x16_bf16 v[88:103], a[76:79], v[36:39], v[88:103]
    s_lshl2_add_u32 s31, s58, s22
    v_exp_f32 v76, v76
    v_exp_f32 v77, v77
    v_exp_f32 v78, v78
    v_exp_f32 v79, v79
    v_smfmac_f32_32x32x32_bf16 a[16:31], a[80:83], v[104:111], v2
    s_lshl_b32 s31, s31, 13
    s_add_u32 s31, s31, 1052672
    v_exp_f32 v80, v80
    v_exp_f32 v81, v81
    v_exp_f32 v82, v82
    v_exp_f32 v83, v83
    v_smfmac_f32_32x32x32_bf16 a[16:31], a[84:87], v[112:119], v2
    s_waitcnt vmcnt(14)
    v_exp_f32 v84, v84
    v_exp_f32 v85, v85
    v_exp_f32 v86, v86
    v_exp_f32 v87, v87
    v_mfma_f32_32x32x16_bf16 v[104:119], a[88:91], a[48:51], 0
    global_load_dwordx4 a[152:155], v1, s[48:49] offset:0 sc1
    v_exp_f32 v88, v88
    v_exp_f32 v89, v89
    v_exp_f32 v90, v90
    v_exp_f32 v91, v91
    v_mfma_f32_32x32x16_bf16 v[104:119], a[92:95], a[52:55], v[104:119]
    global_load_dwordx4 a[156:159], v1, s[48:49] offset:1024 sc1
    v_exp_f32 v92, v92
    v_exp_f32 v93, v93
    v_exp_f32 v94, v94
    v_exp_f32 v95, v95
    v_smfmac_f32_32x32x32_bf16 a[32:47], a[80:83], v[72:79], v2
    v_add_u32 v120, s31, v1
    v_bfe_u32 v230, v0, 3, 1
    v_exp_f32 v96, v96
    v_exp_f32 v97, v97
    v_exp_f32 v98, v98
    v_exp_f32 v99, v99
    v_smfmac_f32_32x32x32_bf16 a[32:47], a[84:87], v[80:87], v2
    v_lshl_add_u32 v230, v207, 2, v230
    v_exp_f32 v100, v100
    v_exp_f32 v101, v101
    v_exp_f32 v102, v102
    v_exp_f32 v103, v103
    v_mfma_f32_32x32x16_bf16 v[72:87], a[88:91], a[56:59], 0
    global_load_dwordx4 a[160:163], v1, s[48:49] offset:2048 sc1
    v_exp_f32 v104, v104
    v_exp_f32 v105, v105
    v_exp_f32 v106, v106
    v_exp_f32 v107, v107
    v_mfma_f32_32x32x16_bf16 v[72:87], a[92:95], a[60:63], v[72:87]
    v_lshl_add_u32 v230, v230, 1, v210
    v_exp_f32 v108, v108
    v_exp_f32 v109, v109
    v_exp_f32 v110, v110
    v_exp_f32 v111, v111
    v_smfmac_f32_32x32x32_bf16 v[16:31], a[80:83], v[88:95], v2
    v_lshl_add_u32 v230, v230, 2, v208
    v_bfe_u32 v231, v0, 2, 1
    v_exp_f32 v112, v112
    v_exp_f32 v113, v113
    v_exp_f32 v114, v114
    v_exp_f32 v115, v115
    v_smfmac_f32_32x32x32_bf16 v[16:31], a[84:87], v[96:103], v2
    v_lshl_add_u32 v230, v230, 1, v231
    v_exp_f32 v116, v116
    v_exp_f32 v117, v117
    v_exp_f32 v118, v118
    v_exp_f32 v119, v119
    v_mfma_f32_32x32x16_bf16 v[88:103], a[88:91], a[64:67], 0
    global_load_dwordx4 a[164:167], v1, s[48:49] offset:3072 sc1
    v_exp_f32 v72, v72
    v_exp_f32 v73, v73
    v_exp_f32 v74, v74
    v_exp_f32 v75, v75
    v_mfma_f32_32x32x16_bf16 v[88:103], a[92:95], a[68:71], v[88:103]
    global_load_dwordx4 a[168:171], v1, s[50:51] offset:-4096 sc1
    v_exp_f32 v76, v76
    v_exp_f32 v77, v77
    v_exp_f32 v78, v78
    v_exp_f32 v79, v79
    v_smfmac_f32_32x32x32_bf16 a[0:15], a[96:99], v[104:111], v2
    global_load_dword v9, v9, s[12:13]
    v_exp_f32 v80, v80
    v_exp_f32 v81, v81
    v_exp_f32 v82, v82
    v_exp_f32 v83, v83
    v_smfmac_f32_32x32x32_bf16 a[0:15], a[100:103], v[112:119], v2
    v_lshlrev_b32 v121, 3, v230
    v_exp_f32 v84, v84
    v_exp_f32 v85, v85
    v_exp_f32 v86, v86
    v_exp_f32 v87, v87
    v_mfma_f32_32x32x16_bf16 v[104:119], a[88:91], v[32:35], 0
    global_load_dwordx4 a[172:175], v1, s[50:51] offset:-3072 sc1
    v_exp_f32 v88, v88
    v_exp_f32 v89, v89
    v_exp_f32 v90, v90
    v_exp_f32 v91, v91
    v_mfma_f32_32x32x16_bf16 v[104:119], a[92:95], v[36:39], v[104:119]
    s_lshl_b32 s34, s32, 11
    s_mov_b32 exec_lo, 0x1111
    s_mov_b32 exec_hi, 0x1111
    v_add_u32 v121, s34, v121
    s_mov_b64 exec, -1
    v_exp_f32 v92, v92
    v_exp_f32 v93, v93
    v_exp_f32 v94, v94
    v_exp_f32 v95, v95
    v_smfmac_f32_32x32x32_bf16 a[16:31], a[96:99], v[72:79], v2
    s_lshl_b32 s31, s33, 10
    s_add_u32 s31, s31, s26
    v_exp_f32 v96, v96
    v_exp_f32 v97, v97
    v_exp_f32 v98, v98
    v_exp_f32 v99, v99
    v_smfmac_f32_32x32x32_bf16 a[16:31], a[100:103], v[80:87], v2
    s_waitcnt vmcnt(15)
    v_exp_f32 v100, v100
    v_exp_f32 v101, v101
    v_exp_f32 v102, v102
    v_exp_f32 v103, v103
    v_mfma_f32_32x32x16_bf16 v[72:87], a[104:107], a[48:51], 0
    global_load_dwordx4 a[176:179], v1, s[50:51] offset:-2048 sc1
    v_exp_f32 v104, v104
    v_exp_f32 v105, v105
    v_exp_f32 v106, v106
    v_exp_f32 v107, v107
    v_mfma_f32_32x32x16_bf16 v[72:87], a[108:111], a[52:55], v[72:87]
    global_load_dwordx4 a[180:183], v1, s[50:51] offset:-1024 sc1
    v_exp_f32 v108, v108
    v_exp_f32 v109, v109
    v_exp_f32 v110, v110
    v_exp_f32 v111, v111
    v_smfmac_f32_32x32x32_bf16 a[32:47], a[96:99], v[88:95], v2
    s_mov_b64 exec, 1
    global_store_dword v5, v4, s[20:21] offset:128 sc1
    s_mov_b64 exec, -1
    v_exp_f32 v112, v112
    v_exp_f32 v113, v113
    v_exp_f32 v114, v114
    v_exp_f32 v115, v115
    v_smfmac_f32_32x32x32_bf16 a[32:47], a[100:103], v[96:103], v2
    v_lshl_add_u32 v230, v207, 9, s31
    v_exp_f32 v116, v116
    v_exp_f32 v117, v117
    v_exp_f32 v118, v118
    v_exp_f32 v119, v119
    v_mfma_f32_32x32x16_bf16 v[88:103], a[104:107], a[56:59], 0
    global_load_dwordx4 a[184:187], v1, s[50:51] offset:0 sc1
    v_exp_f32 v72, v72
    v_exp_f32 v73, v73
    v_exp_f32 v74, v74
    v_exp_f32 v75, v75
    v_mfma_f32_32x32x16_bf16 v[88:103], a[108:111], a[60:63], v[88:103]
    s_movk_i32 s39, 1792
    v_exp_f32 v76, v76
    v_exp_f32 v77, v77
    v_exp_f32 v78, v78
    v_exp_f32 v79, v79
    v_smfmac_f32_32x32x32_bf16 v[16:31], a[96:99], v[104:111], v2
    s_lshl_b32 s34, s24, 5
    v_subrev_u32 v231, s32, v206
    v_exp_f32 v80, v80
    v_exp_f32 v81, v81
    v_exp_f32 v82, v82
    v_exp_f32 v83, v83
    v_smfmac_f32_32x32x32_bf16 v[16:31], a[100:103], v[112:119], v2
    v_and_b32 v231, 31, v231
    v_exp_f32 v84, v84
    v_exp_f32 v85, v85
    v_exp_f32 v86, v86
    v_exp_f32 v87, v87
    v_mfma_f32_32x32x16_bf16 v[104:119], a[104:107], a[64:67], 0
    global_load_dwordx4 a[188:191], v1, s[50:51] offset:1024 sc1
    v_exp_f32 v88, v88
    v_exp_f32 v89, v89
    v_exp_f32 v90, v90
    v_exp_f32 v91, v91
    v_mfma_f32_32x32x16_bf16 v[104:119], a[108:111], a[68:71], v[104:119]
    global_load_dwordx4 a[192:195], v1, s[50:51] offset:2048 sc1
    v_exp_f32 v92, v92
    v_exp_f32 v93, v93
    v_exp_f32 v94, v94
    v_exp_f32 v95, v95
    v_smfmac_f32_32x32x32_bf16 a[0:15], a[112:115], v[72:79], v2
    v_add_lshl_u32 v231, v231, s34, 1
    v_mad_u32_u24 v230, v230, s39, v231
    v_exp_f32 v96, v96
    v_exp_f32 v97, v97
    v_exp_f32 v98, v98
    v_exp_f32 v99, v99
    v_smfmac_f32_32x32x32_bf16 a[0:15], a[116:119], v[80:87], v2
    s_sub_u32 s31, 0, s32
    v_exp_f32 v100, v100
    v_exp_f32 v101, v101
    v_exp_f32 v102, v102
    v_exp_f32 v103, v103
    v_mfma_f32_32x32x16_bf16 v[72:87], a[104:107], v[32:35], 0
    global_load_dwordx4 a[196:199], v1, s[50:51] offset:3072 sc1
    v_exp_f32 v104, v104
    v_exp_f32 v105, v105
    v_exp_f32 v106, v106
    v_exp_f32 v107, v107
    v_mfma_f32_32x32x16_bf16 v[72:87], a[108:111], v[36:39], v[72:87]
    v_xor_b32 v230, s31, v230
    v_exp_f32 v108, v108
    v_exp_f32 v109, v109
    v_exp_f32 v110, v110
    v_exp_f32 v111, v111
    v_smfmac_f32_32x32x32_bf16 a[16:31], a[112:115], v[88:95], v2
    s_mul_i32 s34, s32, 3670911
    s_addk_i32 s34, 896
    v_exp_f32 v112, v112
    v_exp_f32 v113, v113
    v_exp_f32 v114, v114
    v_exp_f32 v115, v115
    v_smfmac_f32_32x32x32_bf16 a[16:31], a[116:119], v[96:103], v2
    s_waitcnt vmcnt(18)
    v_exp_f32 v116, v116
    v_exp_f32 v117, v117
    v_exp_f32 v118, v118
    v_exp_f32 v119, v119
    v_mfma_f32_32x32x16_bf16 v[88:103], a[120:123], a[48:51], 0
    global_load_dwordx4 v[192:195], v1, s[52:53] offset:-4096 sc1
    v_exp_f32 v72, v72
    v_exp_f32 v73, v73
    v_exp_f32 v74, v74
    v_exp_f32 v75, v75
    v_mfma_f32_32x32x16_bf16 v[88:103], a[124:127], a[52:55], v[88:103]
    global_load_dwordx4 v[196:199], v1, s[52:53] offset:-3072 sc1
    v_exp_f32 v76, v76
    v_exp_f32 v77, v77
    v_exp_f32 v78, v78
    v_exp_f32 v79, v79
    v_smfmac_f32_32x32x32_bf16 a[32:47], a[112:115], v[104:111], v2
    v_add_u32 v125, s34, v230
    s_xor_b32 s65, s31, s38
    v_exp_f32 v80, v80
    v_exp_f32 v81, v81
    v_exp_f32 v82, v82
    v_exp_f32 v83, v83
    v_smfmac_f32_32x32x32_bf16 a[32:47], a[116:119], v[112:119], v2
    s_add_u32 s65, s65, s32
    v_exp_f32 v84, v84
    v_exp_f32 v85, v85
    v_exp_f32 v86, v86
    v_exp_f32 v87, v87
    v_mfma_f32_32x32x16_bf16 v[104:119], a[120:123], a[56:59], 0
    global_load_dwordx4 v[200:203], v1, s[52:53] offset:-2048 sc1
    v_exp_f32 v88, v88
    v_exp_f32 v89, v89
    v_exp_f32 v90, v90
    v_exp_f32 v91, v91
    v_mfma_f32_32x32x16_bf16 v[104:119], a[124:127], a[60:63], v[104:119]
    s_mul_i32 s31, s58, 57344
    v_exp_f32 v92, v92
    v_exp_f32 v93, v93
    v_exp_f32 v94, v94
    v_exp_f32 v95, v95
    v_smfmac_f32_32x32x32_bf16 v[16:31], a[112:115], v[72:79], v2
    s_lshl2_add_u32 s34, s35, s22
    s_lshl_b32 s34, s34, 6
    v_exp_f32 v96, v96
    v_exp_f32 v97, v97
    v_exp_f32 v98, v98
    v_exp_f32 v99, v99
    v_smfmac_f32_32x32x32_bf16 v[16:31], a[116:119], v[80:87], v2
    s_add_u32 s31, s31, s34
    v_exp_f32 v100, v100
    v_exp_f32 v101, v101
    v_exp_f32 v102, v102
    v_exp_f32 v103, v103
    v_mfma_f32_32x32x16_bf16 v[72:87], a[120:123], a[64:67], 0
    global_load_dwordx4 v[216:219], v1, s[52:53] offset:-1024 sc1
    v_exp_f32 v104, v104
    v_exp_f32 v105, v105
    v_exp_f32 v106, v106
    v_exp_f32 v107, v107
    v_mfma_f32_32x32x16_bf16 v[72:87], a[124:127], a[68:71], v[72:87]
    global_load_dwordx4 v[220:223], v1, s[52:53] offset:0 sc1
    v_exp_f32 v108, v108
    v_exp_f32 v109, v109
    v_exp_f32 v110, v110
    v_exp_f32 v111, v111
    v_smfmac_f32_32x32x32_bf16 a[0:15], a[128:131], v[88:95], v2
    s_addk_i32 s31, 3584
    v_lshl_add_u32 v230, v206, 1, s31
    v_exp_f32 v112, v112
    v_exp_f32 v113, v113
    v_exp_f32 v114, v114
    v_exp_f32 v115, v115
    v_smfmac_f32_32x32x32_bf16 a[0:15], a[132:135], v[96:103], v2
    v_mul_u32_u24 v231, 7168, v207
    v_exp_f32 v116, v116
    v_exp_f32 v117, v117
    v_exp_f32 v118, v118
    v_exp_f32 v119, v119
    v_mfma_f32_32x32x16_bf16 v[88:103], a[120:123], v[32:35], 0
    global_load_dwordx4 v[224:227], v1, s[52:53] offset:1024 sc1
    v_exp_f32 v72, v72
    v_exp_f32 v73, v73
    v_exp_f32 v74, v74
    v_exp_f32 v75, v75
    v_mfma_f32_32x32x16_bf16 v[88:103], a[124:127], v[36:39], v[88:103]
    v_add_u32 v126, v230, v231
    v_exp_f32 v76, v76
    v_exp_f32 v77, v77
    v_exp_f32 v78, v78
    v_exp_f32 v79, v79
    v_smfmac_f32_32x32x32_bf16 a[16:31], a[128:131], v[104:111], v2
    v_add_u32 v6, v15, v1
    v_exp_f32 v80, v80
    v_exp_f32 v81, v81
    v_exp_f32 v82, v82
    v_exp_f32 v83, v83
    v_smfmac_f32_32x32x32_bf16 a[16:31], a[132:135], v[112:119], v2
    s_waitcnt vmcnt(20)
    v_exp_f32 v84, v84
    v_exp_f32 v85, v85
    v_exp_f32 v86, v86
    v_exp_f32 v87, v87
    v_mfma_f32_32x32x16_bf16 v[104:119], a[136:139], a[48:51], 0
    global_load_dwordx4 v[236:239], v1, s[52:53] offset:2048 sc1
    v_exp_f32 v88, v88
    v_exp_f32 v89, v89
    v_exp_f32 v90, v90
    v_exp_f32 v91, v91
    v_mfma_f32_32x32x16_bf16 v[104:119], a[140:143], a[52:55], v[104:119]
    global_load_dwordx4 v[244:247], v1, s[52:53] offset:3072 sc1
    v_exp_f32 v92, v92
    v_exp_f32 v93, v93
    v_exp_f32 v94, v94
    v_exp_f32 v95, v95
    v_smfmac_f32_32x32x32_bf16 a[32:47], a[128:131], v[72:79], v2
    global_load_dword v6, v6, s[20:21]
    v_exp_f32 v96, v96
    v_exp_f32 v97, v97
    v_exp_f32 v98, v98
    v_exp_f32 v99, v99
    v_smfmac_f32_32x32x32_bf16 a[32:47], a[132:135], v[80:87], v2
    s_lshl_b32 s31, s24, 4
    v_exp_f32 v100, v100
    v_exp_f32 v101, v101
    v_exp_f32 v102, v102
    v_exp_f32 v103, v103
    v_mfma_f32_32x32x16_bf16 v[72:87], a[136:139], a[56:59], 0
    global_load_dwordx4 v[248:251], v1, s[54:55] offset:-4096 sc1
    v_exp_f32 v104, v104
    v_exp_f32 v105, v105
    v_exp_f32 v106, v106
    v_exp_f32 v107, v107
    v_mfma_f32_32x32x16_bf16 v[72:87], a[140:143], a[60:63], v[72:87]
    s_or_b32 s59, s59, 57344
    v_exp_f32 v108, v108
    v_exp_f32 v109, v109
    v_exp_f32 v110, v110
    v_exp_f32 v111, v111
    v_smfmac_f32_32x32x32_bf16 v[16:31], a[128:131], v[88:95], v2
    v_xor_b32 v0, s31, v1
    v_add_u32 v0, s59, v0
    v_exp_f32 v112, v112
    v_exp_f32 v113, v113
    v_exp_f32 v114, v114
    v_exp_f32 v115, v115
    v_smfmac_f32_32x32x32_bf16 v[16:31], a[132:135], v[96:103], v2
    v_exp_f32 v116, v116
    v_exp_f32 v117, v117
    v_exp_f32 v118, v118
    v_exp_f32 v119, v119
    v_mfma_f32_32x32x16_bf16 v[88:103], a[136:139], a[64:67], 0
    global_load_dwordx4 v[252:255], v1, s[54:55] offset:-3072 sc1
    v_exp_f32 v72, v72
    v_exp_f32 v73, v73
    v_exp_f32 v74, v74
    v_exp_f32 v75, v75
    v_mfma_f32_32x32x16_bf16 v[88:103], a[140:143], a[68:71], v[88:103]
    global_load_dwordx4 v[228:231], v1, s[54:55] offset:-2048 sc1
    v_exp_f32 v76, v76
    v_exp_f32 v77, v77
    v_exp_f32 v78, v78
    v_exp_f32 v79, v79
    v_smfmac_f32_32x32x32_bf16 a[0:15], a[144:147], v[104:111], v2
    v_exp_f32 v80, v80
    v_exp_f32 v81, v81
    v_exp_f32 v82, v82
    v_exp_f32 v83, v83
    v_smfmac_f32_32x32x32_bf16 a[0:15], a[148:151], v[112:119], v2
    v_exp_f32 v84, v84
    v_exp_f32 v85, v85
    v_exp_f32 v86, v86
    v_exp_f32 v87, v87
    v_mfma_f32_32x32x16_bf16 v[104:119], a[136:139], v[32:35], 0
    global_load_dwordx4 v[232:235], v1, s[54:55] offset:-1024 sc1
    v_exp_f32 v88, v88
    v_exp_f32 v89, v89
    v_exp_f32 v90, v90
    v_exp_f32 v91, v91
    v_mfma_f32_32x32x16_bf16 v[104:119], a[140:143], v[36:39], v[104:119]
    v_exp_f32 v92, v92
    v_exp_f32 v93, v93
    v_exp_f32 v94, v94
    v_exp_f32 v95, v95
    v_smfmac_f32_32x32x32_bf16 a[16:31], a[144:147], v[72:79], v2
    v_exp_f32 v96, v96
    v_exp_f32 v97, v97
    v_exp_f32 v98, v98
    v_exp_f32 v99, v99
    v_smfmac_f32_32x32x32_bf16 a[16:31], a[148:151], v[80:87], v2
    s_waitcnt vmcnt(23)
    v_exp_f32 v100, v100
    v_exp_f32 v101, v101
    v_exp_f32 v102, v102
    v_exp_f32 v103, v103
    v_mfma_f32_32x32x16_bf16 v[72:87], a[152:155], a[48:51], 0
    global_load_dwordx4 v[240:243], v1, s[54:55] offset:0 sc1
    v_exp_f32 v104, v104
    v_exp_f32 v105, v105
    v_exp_f32 v106, v106
    v_exp_f32 v107, v107
    v_mfma_f32_32x32x16_bf16 v[72:87], a[156:159], a[52:55], v[72:87]
    global_load_dwordx4 v[212:215], v1, s[54:55] offset:1024 sc1
    v_exp_f32 v108, v108
    v_exp_f32 v109, v109
    v_exp_f32 v110, v110
    v_exp_f32 v111, v111
    v_smfmac_f32_32x32x32_bf16 a[32:47], a[144:147], v[88:95], v2
    v_exp_f32 v112, v112
    v_exp_f32 v113, v113
    v_exp_f32 v114, v114
    v_exp_f32 v115, v115
    v_smfmac_f32_32x32x32_bf16 a[32:47], a[148:151], v[96:103], v2
    v_exp_f32 v116, v116
    v_exp_f32 v117, v117
    v_exp_f32 v118, v118
    v_exp_f32 v119, v119
    v_mfma_f32_32x32x16_bf16 v[88:103], a[152:155], a[56:59], 0
    global_load_dwordx4 v[208:211], v1, s[54:55] offset:2048 sc1
    v_exp_f32 v72, v72
    v_exp_f32 v73, v73
    v_exp_f32 v74, v74
    v_exp_f32 v75, v75
    v_mfma_f32_32x32x16_bf16 v[88:103], a[156:159], a[60:63], v[88:103]
    v_exp_f32 v76, v76
    v_exp_f32 v77, v77
    v_exp_f32 v78, v78
    v_exp_f32 v79, v79
    v_smfmac_f32_32x32x32_bf16 v[16:31], a[144:147], v[104:111], v2
    v_exp_f32 v80, v80
    v_exp_f32 v81, v81
    v_exp_f32 v82, v82
    v_exp_f32 v83, v83
    v_smfmac_f32_32x32x32_bf16 v[16:31], a[148:151], v[112:119], v2
    v_exp_f32 v84, v84
    v_exp_f32 v85, v85
    v_exp_f32 v86, v86
    v_exp_f32 v87, v87
    v_mfma_f32_32x32x16_bf16 v[104:119], a[152:155], a[64:67], 0
    global_load_dwordx4 v[204:207], v1, s[54:55] offset:3072 sc1
    v_exp_f32 v88, v88
    v_exp_f32 v89, v89
    v_exp_f32 v90, v90
    v_exp_f32 v91, v91
    v_mfma_f32_32x32x16_bf16 v[104:119], a[156:159], a[68:71], v[104:119]
    v_exp_f32 v92, v92
    v_exp_f32 v93, v93
    v_exp_f32 v94, v94
    v_exp_f32 v95, v95
    v_smfmac_f32_32x32x32_bf16 a[0:15], a[160:163], v[72:79], v2
    s_mov_b32 m0, s70
    v_exp_f32 v96, v96
    v_exp_f32 v97, v97
    v_exp_f32 v98, v98
    v_exp_f32 v99, v99
    v_smfmac_f32_32x32x32_bf16 a[0:15], a[164:167], v[80:87], v2
    v_exp_f32 v100, v100
    v_exp_f32 v101, v101
    v_exp_f32 v102, v102
    v_exp_f32 v103, v103
    v_mfma_f32_32x32x16_bf16 v[72:87], a[152:155], v[32:35], 0
    global_load_dword v8, v7, s[20:21] offset:128 sc1
    v_exp_f32 v104, v104
    v_exp_f32 v105, v105
    v_exp_f32 v106, v106
    v_exp_f32 v107, v107
    v_mfma_f32_32x32x16_bf16 v[72:87], a[156:159], v[36:39], v[72:87]
    v_exp_f32 v108, v108
    v_exp_f32 v109, v109
    v_exp_f32 v110, v110
    v_exp_f32 v111, v111
    v_smfmac_f32_32x32x32_bf16 a[16:31], a[160:163], v[88:95], v2
    global_load_lds_dwordx4 v3, s[12:13] offset:0
    v_exp_f32 v112, v112
    v_exp_f32 v113, v113
    v_exp_f32 v114, v114
    v_exp_f32 v115, v115
    v_smfmac_f32_32x32x32_bf16 a[16:31], a[164:167], v[96:103], v2
    s_waitcnt vmcnt(24)
    s_addk_i32 m0, -2560
    v_exp_f32 v116, v116
    v_exp_f32 v117, v117
    v_exp_f32 v118, v118
    v_exp_f32 v119, v119
    v_mfma_f32_32x32x16_bf16 v[88:103], a[168:171], a[48:51], 0
    v_exp_f32 v72, v72
    v_exp_f32 v73, v73
    v_exp_f32 v74, v74
    v_exp_f32 v75, v75
    v_mfma_f32_32x32x16_bf16 v[88:103], a[172:175], a[52:55], v[88:103]
    v_exp_f32 v76, v76
    v_exp_f32 v77, v77
    v_exp_f32 v78, v78
    v_exp_f32 v79, v79
    v_smfmac_f32_32x32x32_bf16 a[32:47], a[160:163], v[104:111], v2
    global_load_lds_dwordx4 v3, s[12:13] offset:3584
    v_exp_f32 v80, v80
    v_exp_f32 v81, v81
    v_exp_f32 v82, v82
    v_exp_f32 v83, v83
    v_smfmac_f32_32x32x32_bf16 a[32:47], a[164:167], v[112:119], v2
    s_addk_i32 m0, 4608
    s_add_u32 s12, s12, 7168
    s_addc_u32 s13, s13, 0
    v_exp_f32 v84, v84
    v_exp_f32 v85, v85
    v_exp_f32 v86, v86
    v_exp_f32 v87, v87
    v_mfma_f32_32x32x16_bf16 v[104:119], a[168:171], a[56:59], 0
    global_load_lds_dwordx4 v3, s[12:13] offset:0
    v_exp_f32 v88, v88
    v_exp_f32 v89, v89
    v_exp_f32 v90, v90
    v_exp_f32 v91, v91
    v_mfma_f32_32x32x16_bf16 v[104:119], a[172:175], a[60:63], v[104:119]
    s_addk_i32 m0, -2560
    v_exp_f32 v92, v92
    v_exp_f32 v93, v93
    v_exp_f32 v94, v94
    v_exp_f32 v95, v95
    v_smfmac_f32_32x32x32_bf16 v[16:31], a[160:163], v[72:79], v2
    global_load_lds_dwordx4 v3, s[12:13] offset:3584
    v_exp_f32 v96, v96
    v_exp_f32 v97, v97
    v_exp_f32 v98, v98
    v_exp_f32 v99, v99
    v_smfmac_f32_32x32x32_bf16 v[16:31], a[164:167], v[80:87], v2
    s_addk_i32 m0, 4608
    v_exp_f32 v100, v100
    v_exp_f32 v101, v101
    v_exp_f32 v102, v102
    v_exp_f32 v103, v103
    v_mfma_f32_32x32x16_bf16 v[72:87], a[168:171], a[64:67], 0
    v_exp_f32 v104, v104
    v_exp_f32 v105, v105
    v_exp_f32 v106, v106
    v_exp_f32 v107, v107
    v_mfma_f32_32x32x16_bf16 v[72:87], a[172:175], a[68:71], v[72:87]
    s_add_u32 s12, s12, 7168
    s_addc_u32 s13, s13, 0
    v_exp_f32 v108, v108
    v_exp_f32 v109, v109
    v_exp_f32 v110, v110
    v_exp_f32 v111, v111
    v_smfmac_f32_32x32x32_bf16 a[0:15], a[176:179], v[88:95], v2
    global_load_lds_dwordx4 v3, s[12:13] offset:0
    v_exp_f32 v112, v112
    v_exp_f32 v113, v113
    v_exp_f32 v114, v114
    v_exp_f32 v115, v115
    v_smfmac_f32_32x32x32_bf16 a[0:15], a[180:183], v[96:103], v2
    s_waitcnt vmcnt(23)
    s_addk_i32 m0, -2560
    v_exp_f32 v116, v116
    v_exp_f32 v117, v117
    v_exp_f32 v118, v118
    v_exp_f32 v119, v119
    v_mfma_f32_32x32x16_bf16 v[88:103], a[184:187], a[48:51], 0
    v_exp_f32 v72, v72
    v_exp_f32 v73, v73
    v_exp_f32 v74, v74
    v_exp_f32 v75, v75
    v_mfma_f32_32x32x16_bf16 v[88:103], a[188:191], a[52:55], v[88:103]
    v_exp_f32 v76, v76
    v_exp_f32 v77, v77
    v_exp_f32 v78, v78
    v_exp_f32 v79, v79
    v_smfmac_f32_32x32x32_bf16 a[16:31], a[176:179], v[104:111], v2
    global_load_lds_dwordx4 v3, s[12:13] offset:3584
    v_exp_f32 v80, v80
    v_exp_f32 v81, v81
    v_exp_f32 v82, v82
    v_exp_f32 v83, v83
    v_smfmac_f32_32x32x32_bf16 a[16:31], a[180:183], v[112:119], v2
    s_addk_i32 m0, 4608
    s_add_u32 s12, s12, 7168
    s_addc_u32 s13, s13, 0
    v_exp_f32 v84, v84
    v_exp_f32 v85, v85
    v_exp_f32 v86, v86
    v_exp_f32 v87, v87
    v_mfma_f32_32x32x16_bf16 v[104:119], a[184:187], a[56:59], 0
    global_load_lds_dwordx4 v3, s[12:13] offset:0
    v_exp_f32 v88, v88
    v_exp_f32 v89, v89
    v_exp_f32 v90, v90
    v_exp_f32 v91, v91
    v_mfma_f32_32x32x16_bf16 v[104:119], a[188:191], a[60:63], v[104:119]
    s_addk_i32 m0, -2560
    v_exp_f32 v92, v92
    v_exp_f32 v93, v93
    v_exp_f32 v94, v94
    v_exp_f32 v95, v95
    v_smfmac_f32_32x32x32_bf16 a[32:47], a[176:179], v[72:79], v2
    global_load_lds_dwordx4 v3, s[12:13] offset:3584
    v_exp_f32 v96, v96
    v_exp_f32 v97, v97
    v_exp_f32 v98, v98
    v_exp_f32 v99, v99
    v_smfmac_f32_32x32x32_bf16 a[32:47], a[180:183], v[80:87], v2
    s_waitcnt vmcnt(8)
    v_cmp_ne_u32 vcc, s36, v8
    s_addk_i32 m0, 4608
    v_exp_f32 v100, v100
    v_exp_f32 v101, v101
    v_exp_f32 v102, v102
    v_exp_f32 v103, v103
    v_mfma_f32_32x32x16_bf16 v[72:87], a[184:187], a[64:67], 0
    s_cbranch_vccnz L_p2
L_p2r:
    s_add_u32 s12, s12, 7168
    s_addc_u32 s13, s13, 0
    v_exp_f32 v104, v104
    v_exp_f32 v105, v105
    v_exp_f32 v106, v106
    v_exp_f32 v107, v107
    v_mfma_f32_32x32x16_bf16 v[72:87], a[188:191], a[68:71], v[72:87]
    global_load_dwordx4 a[200:203], v14, s[20:21] offset:0 sc1
    v_exp_f32 v108, v108
    v_exp_f32 v109, v109
    v_exp_f32 v110, v110
    v_exp_f32 v111, v111
    v_smfmac_f32_32x32x32_bf16 a[0:15], a[192:195], v[88:95], v2
    global_load_dwordx4 a[204:207], v14, s[20:21] offset:1024 sc1
    v_exp_f32 v112, v112
    v_exp_f32 v113, v113
    v_exp_f32 v114, v114
    v_exp_f32 v115, v115
    v_smfmac_f32_32x32x32_bf16 a[0:15], a[196:199], v[96:103], v2
    global_load_dwordx4 a[208:211], v0, s[20:21] offset:0 sc1
    v_exp_f32 v116, v116
    v_exp_f32 v117, v117
    v_exp_f32 v118, v118
    v_exp_f32 v119, v119
    v_mfma_f32_32x32x16_bf16 v[88:103], v[192:195], a[48:51], 0
    global_load_dwordx4 a[212:215], v0, s[20:21] offset:1024 sc1
    v_exp_f32 v72, v72
    v_exp_f32 v73, v73
    v_exp_f32 v74, v74
    v_exp_f32 v75, v75
    v_mfma_f32_32x32x16_bf16 v[88:103], v[196:199], a[52:55], v[88:103]
    v_exp_f32 v76, v76
    v_exp_f32 v77, v77
    v_exp_f32 v78, v78
    v_exp_f32 v79, v79
    v_smfmac_f32_32x32x32_bf16 a[16:31], a[192:195], v[104:111], v2
    global_load_lds_dwordx4 v3, s[12:13] offset:0
    v_exp_f32 v80, v80
    v_exp_f32 v81, v81
    v_exp_f32 v82, v82
    v_exp_f32 v83, v83
    v_smfmac_f32_32x32x32_bf16 a[16:31], a[196:199], v[112:119], v2
    s_addk_i32 m0, -2560
    v_exp_f32 v84, v84
    v_exp_f32 v85, v85
    v_exp_f32 v86, v86
    v_exp_f32 v87, v87
    v_mfma_f32_32x32x16_bf16 v[104:119], v[220:223], a[48:51], 0
    v_exp_f32 v88, v88
    v_exp_f32 v89, v89
    v_exp_f32 v90, v90
    v_exp_f32 v91, v91
    v_mfma_f32_32x32x16_bf16 v[104:119], v[224:227], a[52:55], v[104:119]
    v_exp_f32 v92, v92
    v_exp_f32 v93, v93
    v_exp_f32 v94, v94
    v_exp_f32 v95, v95
    v_smfmac_f32_32x32x32_bf16 a[32:47], a[192:195], v[72:79], v2
    global_load_lds_dwordx4 v3, s[12:13] offset:3584
    v_exp_f32 v96, v96
    v_exp_f32 v97, v97
    v_exp_f32 v98, v98
    v_exp_f32 v99, v99
    v_smfmac_f32_32x32x32_bf16 a[32:47], a[196:199], v[80:87], v2
    s_addk_i32 m0, 4608
    v_exp_f32 v100, v100
    v_exp_f32 v101, v101
    v_exp_f32 v102, v102
    v_exp_f32 v103, v103
    v_mfma_f32_32x32x16_bf16 v[72:87], v[248:251], a[48:51], 0
    v_exp_f32 v104, v104
    v_exp_f32 v105, v105
    v_exp_f32 v106, v106
    v_exp_f32 v107, v107
    v_mfma_f32_32x32x16_bf16 v[72:87], v[252:255], a[52:55], v[72:87]
    s_add_u32 s12, s12, 7168
    s_addc_u32 s13, s13, 0
    v_exp_f32 v108, v108
    v_exp_f32 v109, v109
    v_exp_f32 v110, v110
    v_exp_f32 v111, v111
    v_smfmac_f32_32x32x32_bf16 a[0:15], v[200:203], v[88:95], v2
    global_load_lds_dwordx4 v3, s[12:13] offset:0
    v_exp_f32 v112, v112
    v_exp_f32 v113, v113
    v_exp_f32 v114, v114
    v_exp_f32 v115, v115
    v_smfmac_f32_32x32x32_bf16 a[0:15], v[216:219], v[96:103], v2
    s_addk_i32 m0, -2560
    v_exp_f32 v116, v116
    v_exp_f32 v117, v117
    v_exp_f32 v118, v118
    v_exp_f32 v119, v119
    v_mfma_f32_32x32x16_bf16 v[88:103], v[240:243], a[48:51], 0
    v_exp_f32 v72, v72
    v_exp_f32 v73, v73
    v_exp_f32 v74, v74
    v_exp_f32 v75, v75
    v_mfma_f32_32x32x16_bf16 v[88:103], v[212:215], a[52:55], v[88:103]
    v_exp_f32 v76, v76
    v_exp_f32 v77, v77
    v_exp_f32 v78, v78
    v_exp_f32 v79, v79
    v_smfmac_f32_32x32x32_bf16 a[0:15], v[236:239], v[104:111], v2
    global_load_lds_dwordx4 v3, s[12:13] offset:3584
    v_exp_f32 v80, v80
    v_exp_f32 v81, v81
    v_exp_f32 v82, v82
    v_exp_f32 v83, v83
    v_smfmac_f32_32x32x32_bf16 a[0:15], v[244:247], v[112:119], v2
    s_addk_i32 m0, 4608
    s_add_u32 s12, s12, 7168
    s_addc_u32 s13, s13, 0
    v_exp_f32 v84, v84
    v_exp_f32 v85, v85
    v_exp_f32 v86, v86
    v_exp_f32 v87, v87
    v_mfma_f32_32x32x16_bf16 v[104:119], v[192:195], a[56:59], 0
    global_load_lds_dwordx4 v3, s[12:13] offset:0
    v_exp_f32 v88, v88
    v_exp_f32 v89, v89
    v_exp_f32 v90, v90
    v_exp_f32 v91, v91
    v_mfma_f32_32x32x16_bf16 v[104:119], v[196:199], a[60:63], v[104:119]
    s_addk_i32 m0, -2560
    v_exp_f32 v92, v92
    v_exp_f32 v93, v93
    v_exp_f32 v94, v94
    v_exp_f32 v95, v95
    v_smfmac_f32_32x32x32_bf16 a[0:15], v[228:231], v[72:79], v2
    global_load_lds_dwordx4 v3, s[12:13] offset:3584
    v_exp_f32 v96, v96
    v_exp_f32 v97, v97
    v_exp_f32 v98, v98
    v_exp_f32 v99, v99
    v_smfmac_f32_32x32x32_bf16 a[0:15], v[232:235], v[80:87], v2
    s_addk_i32 m0, 4608
    v_exp_f32 v100, v100
    v_exp_f32 v101, v101
    v_exp_f32 v102, v102
    v_exp_f32 v103, v103
    v_mfma_f32_32x32x16_bf16 v[72:87], v[220:223], a[56:59], 0
    v_exp_f32 v104, v104
    v_exp_f32 v105, v105
    v_exp_f32 v106, v106
    v_exp_f32 v107, v107
    v_mfma_f32_32x32x16_bf16 v[72:87], v[224:227], a[60:63], v[72:87]
    s_add_u32 s12, s12, 7168
    s_addc_u32 s13, s13, 0
    v_exp_f32 v108, v108
    v_exp_f32 v109, v109
    v_exp_f32 v110, v110
    v_exp_f32 v111, v111
    v_smfmac_f32_32x32x32_bf16 a[0:15], v[208:211], v[88:95], v2
    global_load_lds_dwordx4 v3, s[12:13] offset:0
    v_exp_f32 v112, v112
    v_exp_f32 v113, v113
    v_exp_f32 v114, v114
    v_exp_f32 v115, v115
    v_smfmac_f32_32x32x32_bf16 a[0:15], v[204:207], v[96:103], v2
    s_addk_i32 m0, -2560
    v_exp_f32 v116, v116
    v_exp_f32 v117, v117
    v_exp_f32 v118, v118
    v_exp_f32 v119, v119
    v_mfma_f32_32x32x16_bf16 v[88:103], v[248:251], a[56:59], 0
    v_exp_f32 v72, v72
    v_exp_f32 v73, v73
    v_exp_f32 v74, v74
    v_exp_f32 v75, v75
    v_mfma_f32_32x32x16_bf16 v[88:103], v[252:255], a[60:63], v[88:103]
    s_nop 0
    ds_write_b128 v10, a[0:3] offset:0
    v_exp_f32 v76, v76
    v_exp_f32 v77, v77
    v_exp_f32 v78, v78
    v_exp_f32 v79, v79
    v_smfmac_f32_32x32x32_bf16 a[16:31], v[200:203], v[104:111], v2
    global_load_lds_dwordx4 v3, s[12:13] offset:3584
    v_exp_f32 v80, v80
    v_exp_f32 v81, v81
    v_exp_f32 v82, v82
    v_exp_f32 v83, v83
    v_smfmac_f32_32x32x32_bf16 a[16:31], v[216:219], v[112:119], v2
    s_addk_i32 m0, 4608
    s_add_u32 s12, s12, 7168
    s_addc_u32 s13, s13, 0
    ds_write_b128 v10, a[4:7] offset:1024
    v_exp_f32 v84, v84
    v_exp_f32 v85, v85
    v_exp_f32 v86, v86
    v_exp_f32 v87, v87
    v_mfma_f32_32x32x16_bf16 v[104:119], v[240:243], a[56:59], 0
    global_load_lds_dwordx4 v3, s[12:13] offset:0
    v_exp_f32 v88, v88
    v_exp_f32 v89, v89
    v_exp_f32 v90, v90
    v_exp_f32 v91, v91
    v_mfma_f32_32x32x16_bf16 v[104:119], v[212:215], a[60:63], v[104:119]
    s_addk_i32 m0, -2560
    ds_write_b128 v10, a[8:11] offset:2048
    v_exp_f32 v92, v92
    v_exp_f32 v93, v93
    v_exp_f32 v94, v94
    v_exp_f32 v95, v95
    v_smfmac_f32_32x32x32_bf16 a[16:31], v[236:239], v[72:79], v2
    global_load_lds_dwordx4 v3, s[12:13] offset:3584
    v_exp_f32 v96, v96
    v_exp_f32 v97, v97
    v_exp_f32 v98, v98
    v_exp_f32 v99, v99
    v_smfmac_f32_32x32x32_bf16 a[16:31], v[244:247], v[80:87], v2
    s_addk_i32 m0, 4608
    ds_write_b128 v10, a[12:15] offset:3072
    v_exp_f32 v100, v100
    v_exp_f32 v101, v101
    v_exp_f32 v102, v102
    v_exp_f32 v103, v103
    v_mfma_f32_32x32x16_bf16 v[72:87], v[192:195], a[64:67], 0
    v_exp_f32 v104, v104
    v_exp_f32 v105, v105
    v_exp_f32 v106, v106
    v_exp_f32 v107, v107
    v_mfma_f32_32x32x16_bf16 v[72:87], v[196:199], a[68:71], v[72:87]
    s_add_u32 s12, s12, 7168
    s_addc_u32 s13, s13, 0
    v_exp_f32 v108, v108
    v_exp_f32 v109, v109
    v_exp_f32 v110, v110
    v_exp_f32 v111, v111
    v_smfmac_f32_32x32x32_bf16 a[16:31], v[228:231], v[88:95], v2
    global_load_lds_dwordx4 v3, s[12:13] offset:0
    v_exp_f32 v112, v112
    v_exp_f32 v113, v113
    v_exp_f32 v114, v114
    v_exp_f32 v115, v115
    v_smfmac_f32_32x32x32_bf16 a[16:31], v[232:235], v[96:103], v2
    s_addk_i32 m0, -2560
    v_exp_f32 v116, v116
    v_exp_f32 v117, v117
    v_exp_f32 v118, v118
    v_exp_f32 v119, v119
    v_mfma_f32_32x32x16_bf16 v[88:103], v[220:223], a[64:67], 0
    v_exp_f32 v72, v72
    v_exp_f32 v73, v73
    v_exp_f32 v74, v74
    v_exp_f32 v75, v75
    v_mfma_f32_32x32x16_bf16 v[88:103], v[224:227], a[68:71], v[88:103]
    v_exp_f32 v76, v76
    v_exp_f32 v77, v77
    v_exp_f32 v78, v78
    v_exp_f32 v79, v79
    v_smfmac_f32_32x32x32_bf16 a[16:31], v[208:211], v[104:111], v2
    global_load_lds_dwordx4 v3, s[12:13] offset:3584
    v_exp_f32 v80, v80
    v_exp_f32 v81, v81
    v_exp_f32 v82, v82
    v_exp_f32 v83, v83
    v_smfmac_f32_32x32x32_bf16 a[16:31], v[204:207], v[112:119], v2
    s_addk_i32 m0, 4608
    s_add_u32 s12, s12, 7168
    s_addc_u32 s13, s13, 0
    v_exp_f32 v84, v84
    v_exp_f32 v85, v85
    v_exp_f32 v86, v86
    v_exp_f32 v87, v87
    v_mfma_f32_32x32x16_bf16 v[104:119], v[248:251], a[64:67], 0
    global_load_lds_dwordx4 v3, s[12:13] offset:0
    v_exp_f32 v88, v88
    v_exp_f32 v89, v89
    v_exp_f32 v90, v90
    v_exp_f32 v91, v91
    v_mfma_f32_32x32x16_bf16 v[104:119], v[252:255], a[68:71], v[104:119]
    s_addk_i32 m0, -2560
    ds_write_b128 v10, a[16:19] offset:4096
    v_exp_f32 v92, v92
    v_exp_f32 v93, v93
    v_exp_f32 v94, v94
    v_exp_f32 v95, v95
    v_smfmac_f32_32x32x32_bf16 a[32:47], v[200:203], v[72:79], v2
    global_load_lds_dwordx4 v3, s[12:13] offset:3584
    v_exp_f32 v96, v96
    v_exp_f32 v97, v97
    v_exp_f32 v98, v98
    v_exp_f32 v99, v99
    v_smfmac_f32_32x32x32_bf16 a[32:47], v[216:219], v[80:87], v2
    s_addk_i32 m0, 4608
    ds_write_b128 v10, a[20:23] offset:5120
    v_exp_f32 v100, v100
    v_exp_f32 v101, v101
    v_exp_f32 v102, v102
    v_exp_f32 v103, v103
    v_mfma_f32_32x32x16_bf16 v[72:87], v[240:243], a[64:67], 0
    v_exp_f32 v104, v104
    v_exp_f32 v105, v105
    v_exp_f32 v106, v106
    v_exp_f32 v107, v107
    v_mfma_f32_32x32x16_bf16 v[72:87], v[212:215], a[68:71], v[72:87]
    s_add_u32 s12, s12, 7168
    s_addc_u32 s13, s13, 0
    ds_write_b128 v10, a[24:27] offset:6144
    v_exp_f32 v108, v108
    v_exp_f32 v109, v109
    v_exp_f32 v110, v110
    v_exp_f32 v111, v111
    v_smfmac_f32_32x32x32_bf16 a[32:47], v[236:239], v[88:95], v2
    global_load_lds_dwordx4 v3, s[12:13] offset:0
    v_exp_f32 v112, v112
    v_exp_f32 v113, v113
    v_exp_f32 v114, v114
    v_exp_f32 v115, v115
    v_smfmac_f32_32x32x32_bf16 a[32:47], v[244:247], v[96:103], v2
    s_addk_i32 m0, -2560
    ds_write_b128 v10, a[28:31] offset:7168
    v_exp_f32 v116, v116
    v_exp_f32 v117, v117
    v_exp_f32 v118, v118
    v_exp_f32 v119, v119
    v_mfma_f32_32x32x16_bf16 v[88:103], a[168:171], v[32:35], 0
    v_exp_f32 v72, v72
    v_exp_f32 v73, v73
    v_exp_f32 v74, v74
    v_exp_f32 v75, v75
    v_mfma_f32_32x32x16_bf16 v[88:103], a[172:175], v[36:39], v[88:103]
    v_exp_f32 v76, v76
    v_exp_f32 v77, v77
    v_exp_f32 v78, v78
    v_exp_f32 v79, v79
    v_smfmac_f32_32x32x32_bf16 a[32:47], v[228:231], v[104:111], v2
    global_load_lds_dwordx4 v3, s[12:13] offset:3584
    v_exp_f32 v80, v80
    v_exp_f32 v81, v81
    v_exp_f32 v82, v82
    v_exp_f32 v83, v83
    v_smfmac_f32_32x32x32_bf16 a[32:47], v[232:235], v[112:119], v2
    s_addk_i32 m0, 4608
    s_add_u32 s12, s12, 7168
    s_addc_u32 s13, s13, 0
    v_exp_f32 v84, v84
    v_exp_f32 v85, v85
    v_exp_f32 v86, v86
    v_exp_f32 v87, v87
    v_mfma_f32_32x32x16_bf16 v[104:119], a[184:187], v[32:35], 0
    global_load_lds_dwordx4 v3, s[12:13] offset:0
    v_exp_f32 v88, v88
    v_exp_f32 v89, v89
    v_exp_f32 v90, v90
    v_exp_f32 v91, v91
    v_mfma_f32_32x32x16_bf16 v[104:119], a[188:191], v[36:39], v[104:119]
    s_addk_i32 m0, -2560
    v_exp_f32 v92, v92
    v_exp_f32 v93, v93
    v_exp_f32 v94, v94
    v_exp_f32 v95, v95
    v_smfmac_f32_32x32x32_bf16 a[32:47], v[208:211], v[72:79], v2
    global_load_lds_dwordx4 v3, s[12:13] offset:3584
    v_exp_f32 v96, v96
    v_exp_f32 v97, v97
    v_exp_f32 v98, v98
    v_exp_f32 v99, v99
    v_smfmac_f32_32x32x32_bf16 a[32:47], v[204:207], v[80:87], v2
    s_addk_i32 m0, 4608
    v_exp_f32 v100, v100
    v_exp_f32 v101, v101
    v_exp_f32 v102, v102
    v_exp_f32 v103, v103
    v_mfma_f32_32x32x16_bf16 v[72:87], v[192:195], v[32:35], 0
    v_exp_f32 v104, v104
    v_exp_f32 v105, v105
    v_exp_f32 v106, v106
    v_exp_f32 v107, v107
    v_mfma_f32_32x32x16_bf16 v[72:87], v[196:199], v[36:39], v[72:87]
    s_add_u32 s12, s12, 7168
    s_addc_u32 s13, s13, 0
    ds_write_b128 v10, a[32:35] offset:8192
    v_exp_f32 v108, v108
    v_exp_f32 v109, v109
    v_exp_f32 v110, v110
    v_exp_f32 v111, v111
    v_smfmac_f32_32x32x32_bf16 v[16:31], a[176:179], v[88:95], v2
    global_load_lds_dwordx4 v3, s[12:13] offset:0
    v_exp_f32 v112, v112
    v_exp_f32 v113, v113
    v_exp_f32 v114, v114
    v_exp_f32 v115, v115
    v_smfmac_f32_32x32x32_bf16 v[16:31], a[180:183], v[96:103], v2
    s_addk_i32 m0, -2560
    ds_write_b128 v10, a[36:39] offset:9216
    v_exp_f32 v116, v116
    v_exp_f32 v117, v117
    v_exp_f32 v118, v118
    v_exp_f32 v119, v119
    v_mfma_f32_32x32x16_bf16 v[88:103], v[220:223], v[32:35], 0
    v_exp_f32 v72, v72
    v_exp_f32 v73, v73
    v_exp_f32 v74, v74
    v_exp_f32 v75, v75
    v_mfma_f32_32x32x16_bf16 v[88:103], v[224:227], v[36:39], v[88:103]
    ds_write_b128 v10, a[40:43] offset:10240
    v_exp_f32 v76, v76
    v_exp_f32 v77, v77
    v_exp_f32 v78, v78
    v_exp_f32 v79, v79
    v_smfmac_f32_32x32x32_bf16 v[16:31], a[192:195], v[104:111], v2
    global_load_lds_dwordx4 v3, s[12:13] offset:3584
    v_exp_f32 v80, v80
    v_exp_f32 v81, v81
    v_exp_f32 v82, v82
    v_exp_f32 v83, v83
    v_smfmac_f32_32x32x32_bf16 v[16:31], a[196:199], v[112:119], v2
    ds_write_b128 v10, a[44:47] offset:11264
    v_exp_f32 v84, v84
    v_exp_f32 v85, v85
    v_exp_f32 v86, v86
    v_exp_f32 v87, v87
    v_mfma_f32_32x32x16_bf16 v[104:119], v[248:251], v[32:35], 0
    v_exp_f32 v88, v88
    v_exp_f32 v89, v89
    v_exp_f32 v90, v90
    v_exp_f32 v91, v91
    v_mfma_f32_32x32x16_bf16 v[104:119], v[252:255], v[36:39], v[104:119]
    v_exp_f32 v92, v92
    v_exp_f32 v93, v93
    v_exp_f32 v94, v94
    v_exp_f32 v95, v95
    v_smfmac_f32_32x32x32_bf16 v[16:31], v[200:203], v[72:79], v2
    v_exp_f32 v96, v96
    v_exp_f32 v97, v97
    v_exp_f32 v98, v98
    v_exp_f32 v99, v99
    v_smfmac_f32_32x32x32_bf16 v[16:31], v[216:219], v[80:87], v2
    s_waitcnt lgkmcnt(0)
    s_barrier
    v_exp_f32 v100, v100
    v_exp_f32 v101, v101
    v_exp_f32 v102, v102
    v_exp_f32 v103, v103
    v_mfma_f32_32x32x16_bf16 v[72:87], v[240:243], v[32:35], 0
    ds_read_b128 v[128:131], v11 offset:0
    ds_read_b128 v[144:147], v12 offset:0
    v_exp_f32 v104, v104
    v_exp_f32 v105, v105
    v_exp_f32 v106, v106
    v_exp_f32 v107, v107
    v_mfma_f32_32x32x16_bf16 v[72:87], v[212:215], v[36:39], v[72:87]
    ds_read_b128 v[160:163], v13 offset:0
    ds_read_b128 v[132:135], v11 offset:1024
    v_exp_f32 v108, v108
    v_exp_f32 v109, v109
    v_exp_f32 v110, v110
    v_exp_f32 v111, v111
    v_smfmac_f32_32x32x32_bf16 v[16:31], v[236:239], v[88:95], v2
    ds_read_b128 v[148:151], v12 offset:1024
    ds_read_b128 v[164:167], v13 offset:1024
    v_exp_f32 v112, v112
    v_exp_f32 v113, v113
    v_exp_f32 v114, v114
    v_exp_f32 v115, v115
    v_smfmac_f32_32x32x32_bf16 v[16:31], v[244:247], v[96:103], v2
    ds_read_b128 v[136:139], v11 offset:2048
    ds_read_b128 v[152:155], v12 offset:2048
    v_exp_f32 v116, v116
    v_exp_f32 v117, v117
    v_exp_f32 v118, v118
    v_exp_f32 v119, v119
    v_smfmac_f32_32x32x32_bf16 v[16:31], v[228:231], v[104:111], v2
    ds_read_b128 v[168:171], v13 offset:2048
    ds_read_b128 v[140:143], v11 offset:3072
    ds_read_b128 v[156:159], v12 offset:3072
    v_exp_f32 v72, v72
    v_exp_f32 v73, v73
    v_exp_f32 v74, v74
    v_exp_f32 v75, v75
    v_smfmac_f32_32x32x32_bf16 v[16:31], v[232:235], v[112:119], v2
    ds_read_b128 v[172:175], v13 offset:3072
    v_exp_f32 v76, v76
    v_exp_f32 v77, v77
    v_exp_f32 v78, v78
    v_exp_f32 v79, v79
    v_exp_f32 v80, v80
    v_exp_f32 v81, v81
    v_smfmac_f32_32x32x32_bf16 v[16:31], v[208:211], v[72:79], v2
    v_exp_f32 v82, v82
    v_exp_f32 v83, v83
    v_exp_f32 v84, v84
    v_exp_f32 v85, v85
    v_exp_f32 v86, v86
    v_exp_f32 v87, v87
    s_nop 1
    v_smfmac_f32_32x32x32_bf16 v[16:31], v[204:207], v[80:87], v2
    s_waitcnt lgkmcnt(9)
    v_pk_add_f32 v[128:129], v[128:129], v[144:145]
    v_pk_add_f32 v[130:131], v[130:131], v[146:147]
    v_pk_add_f32 v[128:129], v[128:129], v[160:161]
    v_pk_add_f32 v[130:131], v[130:131], v[162:163]
    s_waitcnt lgkmcnt(6)
    v_pk_add_f32 v[132:133], v[132:133], v[148:149]
    v_pk_add_f32 v[134:135], v[134:135], v[150:151]
    v_pk_add_f32 v[132:133], v[132:133], v[164:165]
    v_pk_add_f32 v[134:135], v[134:135], v[166:167]
    s_waitcnt lgkmcnt(3)
    v_pk_add_f32 v[136:137], v[136:137], v[152:153]
    v_pk_add_f32 v[138:139], v[138:139], v[154:155]
    v_pk_add_f32 v[136:137], v[136:137], v[168:169]
    v_pk_add_f32 v[138:139], v[138:139], v[170:171]
    s_waitcnt lgkmcnt(0)
    v_pk_add_f32 v[140:141], v[140:141], v[156:157]
    v_pk_add_f32 v[142:143], v[142:143], v[158:159]
    v_pk_add_f32 v[140:141], v[140:141], v[172:173]
    v_pk_add_f32 v[142:143], v[142:143], v[174:175]
    s_and_b32 s37, s36, 0xffff
    v_pk_add_f32 v[20:21], v[20:21], v[132:133]
    v_pk_add_f32 v[16:17], v[16:17], v[128:129]
    v_rcp_f32 v74, v20
    v_pk_add_f32 v[18:19], v[18:19], v[130:131]
    v_pk_add_f32 v[22:23], v[22:23], v[134:135]
    v_pk_add_f32 v[24:25], v[24:25], v[136:137]
    v_pk_add_f32 v[26:27], v[26:27], v[138:139]
    v_pk_add_f32 v[28:29], v[28:29], v[140:141]
    v_pk_add_f32 v[30:31], v[30:31], v[142:143]
L_norm:
    v_pk_mul_f32 v[16:17], v[16:17], v[74:75] op_sel_hi:[1,0]
    v_pk_mul_f32 v[18:19], v[18:19], v[74:75] op_sel_hi:[1,0]
    v_pk_mul_f32 v[22:23], v[22:23], v[74:75] op_sel_hi:[1,0]
    v_pk_mul_f32 v[24:25], v[24:25], v[74:75] op_sel_hi:[1,0]
    v_pk_mul_f32 v[26:27], v[26:27], v[74:75] op_sel_hi:[1,0]
    v_pk_mul_f32 v[30:31], v[30:31], v[74:75] op_sel_hi:[1,0]
    v_mul_f32 v21, v74, v21
    v_mul_f32 v29, v74, v29
    v_pk_fma_f32 v[72:73], v[16:17], v[18:19], v[22:23]
    v_cvt_pk_bf16_f32 v240, v16, v17
    v_cvt_pk_bf16_f32 v241, v18, v19
    v_pk_fma_f32 v[72:73], v[24:25], v[26:27], v[72:73]
    v_cvt_pk_bf16_f32 v242, 0, v21
    v_cvt_pk_bf16_f32 v243, v22, v23
    v_pk_add_f32 v[72:73], v[30:31], v[72:73]
    v_cvt_pk_bf16_f32 v244, v24, v25
    v_fmac_f32 v72, v21, v29
    v_cvt_pk_bf16_f32 v245, v26, v27
    v_add_f32 v72, v72, v73
    v_cvt_pk_bf16_f32 v246, 0, v29
    v_fmac_f32 v20, 0, v72
    v_cvt_pk_bf16_f32 v247, v30, v31
    v_subrev_u32 v20, 0x17800000, v20
    v_or_b32 v242, s37, v242
    v_cmp_lt_u32 vcc, 0x5f000000, v20
    v_or_b32 v246, s37, v246
    s_cbranch_vccnz L_slow
L_ok:
    global_store_dwordx4 v15, v[240:243], s[20:21] offset:0 sc1
    global_store_dwordx4 v15, v[244:247], s[20:21] offset:1024 sc1
    s_waitcnt vmcnt(2)
    ds_write_b128 v11, a[200:203] offset:0
    ds_write_b128 v11, a[204:207] offset:1024
    ds_write_b128 v11, a[208:211] offset:2048
    ds_write_b128 v11, a[212:215] offset:3072
    s_mov_b32 s66, 0x40000
    ds_read_b64_tr_b16 a[72:73], v122 offset:0
    ds_read_b64_tr_b16 a[74:75], v123 offset:1216
    ds_read_b64_tr_b16 a[76:77], v122 offset:5120
    ds_read_b64_tr_b16 a[78:79], v124 offset:3136
    ds_read_b64_tr_b16 a[80:81], v122 offset:7168
    ds_read_b64_tr_b16 a[82:83], v123 offset:8384
    ds_read_b64_tr_b16 a[84:85], v122 offset:12288
    ds_read_b64_tr_b16 a[86:87], v124 offset:10304
    s_waitcnt lgkmcnt(8)
    s_barrier
    s_or_b32 s31, s2, s22
    s_cbranch_scc1 L_noep
    v_mov_b32 v8, 0
    s_mov_b64 exec, 1
    global_store_dword v8, v4, s[20:21] sc1
    s_mov_b64 exec, -1
L_noep:
    ds_read_b64_tr_b16 v[72:73], v121 offset:36864
    ds_read_b64_tr_b16 v[74:75], v121 offset:37120
    ds_read_b64_tr_b16 v[88:89], v121 offset:12288
    ds_read_b64_tr_b16 v[90:91], v121 offset:12544
    ds_read_b64_tr_b16 v[76:77], v121 offset:37888
    ds_read_b64_tr_b16 v[78:79], v121 offset:38144
    ds_read_b64_tr_b16 v[92:93], v121 offset:13312
    s_waitcnt lgkmcnt(11)
    ds_read_b64_tr_b16 v[94:95], v121 offset:13568
    ds_read_b64_tr_b16 v[80:81], v121 offset:0
    ds_read_b64_tr_b16 v[82:83], v121 offset:256
    ds_read_b64_tr_b16 v[96:97], v121 offset:24576
    s_waitcnt lgkmcnt(11)
    ds_read_b64_tr_b16 v[98:99], v121 offset:24832
    ds_read_b64_tr_b16 v[84:85], v121 offset:1024
    ds_read_b64_tr_b16 v[86:87], v121 offset:1280
    ds_read_b64_tr_b16 v[100:101], v121 offset:25600
    s_waitcnt lgkmcnt(11)
    ds_read_b64_tr_b16 v[102:103], v121 offset:25856
    v_mfma_f32_32x32x16_bf16 v[16:31], v[40:43], v[72:75], 0
    ds_read_b64_tr_b16 a[88:89], v122 offset:14336
    v_subrev_u32 v104, 3670016, v125
    ds_read_b64_tr_b16 a[90:91], v123 offset:15552
    v_min_u32 v104, v104, v125
    ds_read_b64_tr_b16 a[92:93], v122 offset:19456
    s_cmp_eq_u32 s24, 7
    s_cselect_b64 s[68:69], 0, -1
    v_mfma_f32_32x32x16_bf16 v[56:71], v[40:43], v[88:91], 0
    s_waitcnt lgkmcnt(11)
    ds_read_b64_tr_b16 a[94:95], v124 offset:17472
    s_lshl1_add_u32 s35, s35, s32
    s_mov_b32 s39, 0xffff0000
    ds_read_b64_tr_b16 a[96:97], v122 offset:21504
    v_add_u32 v105, s65, v125
    ds_read_b64_tr_b16 a[98:99], v123 offset:22720
    v_add_u32 v106, s65, v105
    v_mfma_f32_32x32x16_bf16 v[16:31], v[44:47], v[76:79], v[16:31]
    ds_read_b64_tr_b16 a[100:101], v122 offset:26624
    v_add_u32 v107, s65, v106
    s_waitcnt lgkmcnt(11)
    ds_read_b64_tr_b16 a[102:103], v124 offset:24640
    v_add_u32 v108, s65, v107
    ds_read_b64_tr_b16 a[104:105], v122 offset:256
    v_add_u32 v109, s65, v108
    v_mfma_f32_32x32x16_bf16 v[56:71], v[44:47], v[92:95], v[56:71]
    ds_read_b64_tr_b16 a[106:107], v123 offset:1472
    v_add_u32 v110, s65, v109
    ds_read_b64_tr_b16 a[108:109], v122 offset:5376
    v_add_u32 v111, s65, v110
    s_waitcnt lgkmcnt(11)
    ds_read_b64_tr_b16 a[110:111], v124 offset:3392
    v_add_u32 v112, s65, v111
    v_mfma_f32_32x32x16_bf16 v[16:31], v[48:51], v[80:83], v[16:31]
    ds_read_b64_tr_b16 a[112:113], v122 offset:7424
    v_add_u32 v113, s65, v112
    ds_read_b64_tr_b16 a[114:115], v123 offset:8640
    v_add_u32 v114, s65, v113
    ds_read_b64_tr_b16 a[116:117], v122 offset:12544
    v_add_u32 v115, s65, v114
    v_mfma_f32_32x32x16_bf16 v[56:71], v[48:51], v[96:99], v[56:71]
    s_waitcnt lgkmcnt(11)
    ds_read_b64_tr_b16 a[118:119], v124 offset:10560
    v_add_u32 v116, s65, v115
    ds_read_b64_tr_b16 a[120:121], v122 offset:14592
    v_add_u32 v117, s65, v116
    ds_read_b64_tr_b16 a[122:123], v123 offset:15808
    v_add_u32 v118, s65, v117
    v_mfma_f32_32x32x16_bf16 v[16:31], v[52:55], v[84:87], v[16:31]
    ds_read_b64_tr_b16 a[124:125], v122 offset:19712
    v_add_u32 v119, s65, v118
    s_waitcnt lgkmcnt(11)
    ds_read_b64_tr_b16 a[126:127], v124 offset:17728
    v_add_u32 v8, 14336, v126
    ds_read_b64_tr_b16 a[128:129], v122 offset:21760
    v_add_u32 v7, 28672, v126
    v_mfma_f32_32x32x16_bf16 v[56:71], v[52:55], v[100:103], v[56:71]
    ds_read_b64_tr_b16 a[130:131], v123 offset:22976
    v_add_u32 v6, 43008, v126
    ds_read_b64_tr_b16 a[132:133], v122 offset:26880
    s_waitcnt lgkmcnt(11)
    ds_read_b64_tr_b16 a[134:135], v124 offset:24896
    ds_read_b64_tr_b16 a[136:137], v122 offset:512
    ds_read_b64_tr_b16 a[138:139], v123 offset:1728
    ds_read_b64_tr_b16 a[140:141], v122 offset:5632
    s_waitcnt lgkmcnt(11)
    ds_read_b64_tr_b16 a[142:143], v124 offset:3648
    ds_read_b64_tr_b16 a[144:145], v122 offset:7680
    ds_read_b64_tr_b16 a[146:147], v123 offset:8896
    ds_read_b64_tr_b16 a[148:149], v122 offset:12800
    s_waitcnt lgkmcnt(11)
    ds_read_b64_tr_b16 a[150:151], v124 offset:10816
    global_load_dwordx4 v[128:131], v120, s[20:21] offset:-4096 sc1
    global_load_dwordx4 v[132:135], v120, s[20:21] offset:-3072 sc1
    ds_read_b64_tr_b16 a[152:153], v122 offset:14848
    ds_read_b64_tr_b16 a[154:155], v123 offset:16064
    global_load_dwordx4 v[136:139], v120, s[20:21] offset:-2048 sc1
    global_load_dwordx4 v[140:143], v120, s[20:21] offset:-1024 sc1
    ds_read_b64_tr_b16 a[156:157], v122 offset:19968
    s_waitcnt lgkmcnt(11)
    ds_read_b64_tr_b16 a[158:159], v124 offset:17984
    global_load_dwordx4 v[144:147], v120, s[20:21] offset:0 sc1
    global_load_dwordx4 v[148:151], v120, s[20:21] offset:1024 sc1
    ds_read_b64_tr_b16 a[160:161], v122 offset:22016
    ds_read_b64_tr_b16 a[162:163], v123 offset:23232
    global_load_dwordx4 v[152:155], v120, s[20:21] offset:2048 sc1
    global_load_dwordx4 v[156:159], v120, s[20:21] offset:3072 sc1
    ds_read_b64_tr_b16 a[164:165], v122 offset:27136
    s_waitcnt lgkmcnt(11)
    ds_read_b64_tr_b16 a[166:167], v124 offset:25152
    ds_read_b64_tr_b16 a[168:169], v122 offset:768
    ds_read_b64_tr_b16 a[170:171], v123 offset:1984
    ds_read_b64_tr_b16 a[172:173], v122 offset:5888
    s_waitcnt lgkmcnt(11)
    ds_read_b64_tr_b16 a[174:175], v124 offset:3904
    ds_read_b64_tr_b16 a[176:177], v122 offset:7936
    ds_read_b64_tr_b16 a[178:179], v123 offset:9152
    ds_read_b64_tr_b16 a[180:181], v122 offset:13056
    s_waitcnt lgkmcnt(11)
    ds_read_b64_tr_b16 a[182:183], v124 offset:11072
    v_pk_add_f32 v[16:17], v[16:17], v[56:57] neg_hi:[0,1]
    v_pk_add_f32 v[18:19], v[18:19], v[58:59] neg_hi:[0,1]
    v_pk_add_f32 v[20:21], v[20:21], v[60:61] neg_hi:[0,1]
    v_pk_add_f32 v[22:23], v[22:23], v[62:63] neg_hi:[0,1]
    v_pk_add_f32 v[24:25], v[24:25], v[64:65] neg_hi:[0,1]
    v_pk_add_f32 v[26:27], v[26:27], v[66:67] neg_hi:[0,1]
    v_pk_add_f32 v[28:29], v[28:29], v[68:69] neg_hi:[0,1]
    v_pk_add_f32 v[30:31], v[30:31], v[70:71] neg_hi:[0,1]
    v_cvt_pk_bf16_f32 v32, v16, v17
    v_cvt_pk_bf16_f32 v33, v18, v19
    v_cvt_pk_bf16_f32 v34, v20, v21
    v_cvt_pk_bf16_f32 v35, v22, v23
    v_cvt_pk_bf16_f32 v36, v24, v25
    v_cvt_pk_bf16_f32 v37, v26, v27
    v_cvt_pk_bf16_f32 v38, v28, v29
    v_cvt_pk_bf16_f32 v39, v30, v31
    s_waitcnt lgkmcnt(0)
    s_barrier
    s_waitcnt vmcnt(7)
L_o0:
    v_cmp_ne_u16 vcc, s36, v130
    v_and_b32 v130, s39, v130
    s_cbranch_vccnz L_r0
L_b0:
    s_nop 0
    v_mfma_f32_32x32x16_bf16 a[0:15], v[128:131], a[72:75], 0
    s_waitcnt vmcnt(6)
L_o1:
    v_cmp_ne_u16 vcc, s36, v134
    v_and_b32 v134, s39, v134
    s_cbranch_vccnz L_r1
L_b1:
    s_nop 0
    v_mfma_f32_32x32x16_bf16 a[0:15], v[132:135], a[76:79], a[0:15]
    s_waitcnt vmcnt(5)
L_o2:
    v_cmp_ne_u16 vcc, s36, v138
    v_and_b32 v138, s39, v138
    s_cbranch_vccnz L_r2
L_b2:
    s_nop 0
    v_mfma_f32_32x32x16_bf16 a[0:15], v[136:139], a[80:83], a[0:15]
    s_waitcnt vmcnt(4)
L_o3:
    v_cmp_ne_u16 vcc, s36, v142
    v_and_b32 v142, s39, v142
    s_cbranch_vccnz L_r3
L_b3:
    s_nop 0
    v_mfma_f32_32x32x16_bf16 a[0:15], v[140:143], a[84:87], a[0:15]
    s_waitcnt vmcnt(3)
L_o4:
    v_cmp_ne_u16 vcc, s36, v146
    v_and_b32 v146, s39, v146
    s_cbranch_vccnz L_r4
L_b4:
    s_nop 0
    v_mfma_f32_32x32x16_bf16 a[0:15], v[144:147], a[88:91], a[0:15]
    s_waitcnt vmcnt(2)
L_o5:
    v_cmp_ne_u16 vcc, s36, v150
    v_and_b32 v150, s39, v150
    s_cbranch_vccnz L_r5
L_b5:
    s_nop 0
    v_mfma_f32_32x32x16_bf16 a[0:15], v[148:151], a[92:95], a[0:15]
    s_waitcnt vmcnt(1)
L_o6:
    v_cmp_ne_u16 vcc, s36, v154
    v_and_b32 v154, s39, v154
    s_cbranch_vccnz L_r6
L_b6:
    s_nop 0
    v_mfma_f32_32x32x16_bf16 a[0:15], v[152:155], a[96:99], a[0:15]
    s_waitcnt vmcnt(0)
L_o7:
    v_cmp_ne_u16 vcc, s36, v158
    v_and_b32 v158, s39, v158
    s_cbranch_vccnz L_r7
L_b7:
    s_nop 0
    v_mfma_f32_32x32x16_bf16 a[0:15], v[156:159], a[100:103], a[0:15]
    v_mfma_f32_32x32x16_bf16 a[16:31], v[128:131], a[104:107], 0
    ds_read_b64_tr_b16 a[184:185], v122 offset:15104
    ds_read_b64_tr_b16 a[186:187], v123 offset:16320
    ds_read_b64_tr_b16 a[188:189], v122 offset:20224
    ds_read_b64_tr_b16 a[190:191], v124 offset:18240
    v_mfma_f32_32x32x16_bf16 a[16:31], v[132:135], a[108:111], a[16:31]
    ds_read_b64_tr_b16 a[192:193], v122 offset:22272
    ds_read_b64_tr_b16 a[194:195], v123 offset:23488
    ds_read_b64_tr_b16 a[196:197], v122 offset:27392
    ds_read_b64_tr_b16 a[198:199], v124 offset:25408
    v_mfma_f32_32x32x16_bf16 a[16:31], v[136:139], a[112:115], a[16:31]
    s_nop 0
    ds_write_b128 v10, a[0:3] offset:0
    v_mfma_f32_32x32x16_bf16 a[16:31], v[140:143], a[116:119], a[16:31]
    ds_write_b128 v10, a[4:7] offset:1024
    v_mfma_f32_32x32x16_bf16 a[16:31], v[144:147], a[120:123], a[16:31]
    ds_write_b128 v10, a[8:11] offset:2048
    v_mfma_f32_32x32x16_bf16 a[16:31], v[148:151], a[124:127], a[16:31]
    ds_write_b128 v10, a[12:15] offset:3072
    v_mfma_f32_32x32x16_bf16 a[16:31], v[152:155], a[128:131], a[16:31]
    s_mov_b64 exec, s[68:69]
    global_store_short v104, v32, s[16:17] sc1
    global_store_short_d16_hi v105, v32, s[16:17] sc1
    global_store_short v106, v33, s[16:17] sc1
    global_store_short_d16_hi v107, v33, s[16:17] sc1
    s_mov_b64 exec, -1
    v_mfma_f32_32x32x16_bf16 a[16:31], v[156:159], a[132:135], a[16:31]
    s_mov_b64 exec, s[68:69]
    global_store_short v108, v34, s[16:17] sc1
    global_store_short_d16_hi v109, v34, s[16:17] sc1
    global_store_short v110, v35, s[16:17] sc1
    global_store_short_d16_hi v111, v35, s[16:17] sc1
    s_mov_b64 exec, -1
    v_mfma_f32_32x32x16_bf16 a[32:47], v[128:131], a[136:139], 0
    s_waitcnt lgkmcnt(0)
    s_barrier
    ds_read_b128 v[160:163], v11 offset:0
    ds_read_b128 v[164:167], v11 offset:1024
    ds_read_b128 v[168:171], v11 offset:2048
    ds_read_b128 v[172:175], v11 offset:3072
    v_mfma_f32_32x32x16_bf16 a[32:47], v[132:135], a[140:143], a[32:47]
    s_mov_b64 exec, s[68:69]
    global_store_short v112, v36, s[16:17] sc1
    global_store_short_d16_hi v113, v36, s[16:17] sc1
    global_store_short v114, v37, s[16:17] sc1
    global_store_short_d16_hi v115, v37, s[16:17] sc1
    s_mov_b64 exec, -1
    v_mfma_f32_32x32x16_bf16 a[32:47], v[136:139], a[144:147], a[32:47]
    ds_write_b128 v10, a[16:19] offset:4096
    v_mfma_f32_32x32x16_bf16 a[32:47], v[140:143], a[148:151], a[32:47]
    ds_write_b128 v10, a[20:23] offset:5120
    v_mfma_f32_32x32x16_bf16 a[32:47], v[144:147], a[152:155], a[32:47]
    ds_write_b128 v10, a[24:27] offset:6144
    v_mfma_f32_32x32x16_bf16 a[32:47], v[148:151], a[156:159], a[32:47]
    ds_write_b128 v10, a[28:31] offset:7168
    v_mfma_f32_32x32x16_bf16 a[32:47], v[152:155], a[160:163], a[32:47]
    s_mov_b64 exec, s[68:69]
    global_store_short v116, v38, s[16:17] sc1
    global_store_short_d16_hi v117, v38, s[16:17] sc1
    global_store_short v118, v39, s[16:17] sc1
    global_store_short_d16_hi v119, v39, s[16:17] sc1
    s_mov_b64 exec, -1
    v_mfma_f32_32x32x16_bf16 a[32:47], v[156:159], a[164:167], a[32:47]
    v_mfma_f32_32x32x16_bf16 v[72:87], v[128:131], a[168:171], 0
    s_waitcnt lgkmcnt(0)
    s_barrier
    ds_read_b128 v[176:179], v12 offset:0
    ds_read_b128 v[180:183], v12 offset:1024
    ds_read_b128 v[184:187], v12 offset:2048
    ds_read_b128 v[188:191], v12 offset:3072
    v_mfma_f32_32x32x16_bf16 v[72:87], v[132:135], a[172:175], v[72:87]
    s_nop 3
    ds_write_b128 v10, a[32:35] offset:8192
    v_mfma_f32_32x32x16_bf16 v[72:87], v[136:139], a[176:179], v[72:87]
    ds_write_b128 v10, a[36:39] offset:9216
    v_mfma_f32_32x32x16_bf16 v[72:87], v[140:143], a[180:183], v[72:87]
    ds_write_b128 v10, a[40:43] offset:10240
    v_mfma_f32_32x32x16_bf16 v[72:87], v[144:147], a[184:187], v[72:87]
    ds_write_b128 v10, a[44:47] offset:11264
    v_mfma_f32_32x32x16_bf16 v[72:87], v[148:151], a[188:191], v[72:87]
    v_mfma_f32_32x32x16_bf16 v[72:87], v[152:155], a[192:195], v[72:87]
    v_mfma_f32_32x32x16_bf16 v[72:87], v[156:159], a[196:199], v[72:87]
    s_waitcnt lgkmcnt(0)
    s_barrier
    ds_read_b128 v[192:195], v13 offset:0
    ds_read_b128 v[196:199], v13 offset:1024
    ds_read_b128 v[200:203], v13 offset:2048
    ds_read_b128 v[204:207], v13 offset:3072
    v_pk_add_f32 v[160:161], v[160:161], v[176:177]
    v_pk_add_f32 v[162:163], v[162:163], v[178:179]
    v_pk_add_f32 v[164:165], v[164:165], v[180:181]
    v_pk_add_f32 v[166:167], v[166:167], v[182:183]
    v_pk_add_f32 v[168:169], v[168:169], v[184:185]
    v_pk_add_f32 v[170:171], v[170:171], v[186:187]
    v_pk_add_f32 v[172:173], v[172:173], v[188:189]
    v_pk_add_f32 v[174:175], v[174:175], v[190:191]
    s_cmp_eq_u32 s35, 7
    s_cbranch_scc1 L_fin
    s_waitcnt lgkmcnt(3)
    v_pk_add_f32 v[160:161], v[160:161], v[192:193]
    v_pk_add_f32 v[162:163], v[162:163], v[194:195]
    s_waitcnt lgkmcnt(2)
    v_pk_add_f32 v[164:165], v[164:165], v[196:197]
    v_pk_add_f32 v[166:167], v[166:167], v[198:199]
    s_waitcnt lgkmcnt(1)
    v_pk_add_f32 v[168:169], v[168:169], v[200:201]
    v_pk_add_f32 v[170:171], v[170:171], v[202:203]
    s_waitcnt lgkmcnt(0)
    v_pk_add_f32 v[172:173], v[172:173], v[204:205]
    v_pk_add_f32 v[174:175], v[174:175], v[206:207]
    v_pk_add_f32 v[72:73], v[72:73], v[160:161]
    v_pk_add_f32 v[74:75], v[74:75], v[162:163]
    v_cvt_pk_bf16_f32 v88, v72, v73
    global_store_short v126, v88, s[16:17] offset:-3584 sc1
    global_store_short_d16_hi v126, v88, s[16:17] offset:-1792 sc1
    v_pk_add_f32 v[76:77], v[76:77], v[164:165]
    v_cvt_pk_bf16_f32 v89, v74, v75
    global_store_short v126, v89, s[16:17] offset:0 sc1
    global_store_short_d16_hi v126, v89, s[16:17] offset:1792 sc1
    v_pk_add_f32 v[78:79], v[78:79], v[166:167]
    v_cvt_pk_bf16_f32 v90, v76, v77
    global_store_short v8, v90, s[16:17] offset:-3584 sc1
    global_store_short_d16_hi v8, v90, s[16:17] offset:-1792 sc1
    v_pk_add_f32 v[80:81], v[80:81], v[168:169]
    v_cvt_pk_bf16_f32 v91, v78, v79
    global_store_short v8, v91, s[16:17] offset:0 sc1
    global_store_short_d16_hi v8, v91, s[16:17] offset:1792 sc1
    v_pk_add_f32 v[82:83], v[82:83], v[170:171]
    v_cvt_pk_bf16_f32 v92, v80, v81
    global_store_short v7, v92, s[16:17] offset:-3584 sc1
    global_store_short_d16_hi v7, v92, s[16:17] offset:-1792 sc1
    v_pk_add_f32 v[84:85], v[84:85], v[172:173]
    v_cvt_pk_bf16_f32 v93, v82, v83
    global_store_short v7, v93, s[16:17] offset:0 sc1
    global_store_short_d16_hi v7, v93, s[16:17] offset:1792 sc1
    v_pk_add_f32 v[86:87], v[86:87], v[174:175]
    v_cvt_pk_bf16_f32 v94, v84, v85
    global_store_short v6, v94, s[16:17] offset:-3584 sc1
    global_store_short_d16_hi v6, v94, s[16:17] offset:-1792 sc1
    v_cvt_pk_bf16_f32 v95, v86, v87
    global_store_short v6, v95, s[16:17] offset:0 sc1
    global_store_short_d16_hi v6, v95, s[16:17] offset:1792 sc1
L_fin:
L_end:
    s_endpgm
L_p1:
    s_mov_b64 exec, 0xffff
    s_mov_b32 s66, 0x40000
L_p1l:
    global_load_dwordx2 v[226:227], v224, s[20:21] offset:0 sc1
L_p1l_c:
    s_waitcnt vmcnt(0)
    v_cmp_ne_u64 vcc, s[36:37], v[226:227]
    s_cbranch_vccz L_p1l_d
    s_sub_u32 s66, s66, 1
    s_cbranch_scc0 L_p1l
L_p1l_d:
    s_mov_b64 exec, -1
    s_branch L_p1r
L_pb:
    s_mov_b32 s66, 0x40000
L_pbl:
    global_load_dwordx2 v[226:227], v224, s[20:21] offset:0 sc1
L_pbl_c:
    s_waitcnt vmcnt(0)
    v_cmp_ne_u64 vcc, s[36:37], v[226:227]
    s_cbranch_vccz L_pbl_d
    s_sub_u32 s66, s66, 1
    s_cbranch_scc0 L_pbl
L_pbl_d:
    s_branch L_pbr
L_p2:
    s_mov_b32 s66, 0x40000
L_p2l:
    global_load_dword v8, v7, s[20:21] offset:128 sc1
L_p2l_c:
    s_waitcnt vmcnt(0)
    v_cmp_ne_u32 vcc, s36, v8
    s_cbranch_vccz L_p2l_d
    s_sub_u32 s66, s66, 1
    s_cbranch_scc0 L_p2l
L_p2l_d:
    s_branch L_p2r
L_r0:
    s_cmp_eq_u32 s66, 0
    s_cbranch_scc1 L_b0
    s_sub_u32 s66, s66, 1
    global_load_dwordx4 v[128:131], v120, s[20:21] offset:-4096 sc1
    global_load_dwordx4 v[132:135], v120, s[20:21] offset:-3072 sc1
    global_load_dwordx4 v[136:139], v120, s[20:21] offset:-2048 sc1
    global_load_dwordx4 v[140:143], v120, s[20:21] offset:-1024 sc1
    global_load_dwordx4 v[144:147], v120, s[20:21] offset:0 sc1
    global_load_dwordx4 v[148:151], v120, s[20:21] offset:1024 sc1
    global_load_dwordx4 v[152:155], v120, s[20:21] offset:2048 sc1
    global_load_dwordx4 v[156:159], v120, s[20:21] offset:3072 sc1
    s_waitcnt vmcnt(7)
    s_branch L_o0
L_r1:
    s_cmp_eq_u32 s66, 0
    s_cbranch_scc1 L_b1
    s_sub_u32 s66, s66, 1
    global_load_dwordx4 v[132:135], v120, s[20:21] offset:-3072 sc1
    global_load_dwordx4 v[136:139], v120, s[20:21] offset:-2048 sc1
    global_load_dwordx4 v[140:143], v120, s[20:21] offset:-1024 sc1
    global_load_dwordx4 v[144:147], v120, s[20:21] offset:0 sc1
    global_load_dwordx4 v[148:151], v120, s[20:21] offset:1024 sc1
    global_load_dwordx4 v[152:155], v120, s[20:21] offset:2048 sc1
    global_load_dwordx4 v[156:159], v120, s[20:21] offset:3072 sc1
    s_waitcnt vmcnt(6)
    s_branch L_o1
L_r2:
    s_cmp_eq_u32 s66, 0
    s_cbranch_scc1 L_b2
    s_sub_u32 s66, s66, 1
    global_load_dwordx4 v[136:139], v120, s[20:21] offset:-2048 sc1
    global_load_dwordx4 v[140:143], v120, s[20:21] offset:-1024 sc1
    global_load_dwordx4 v[144:147], v120, s[20:21] offset:0 sc1
    global_load_dwordx4 v[148:151], v120, s[20:21] offset:1024 sc1
    global_load_dwordx4 v[152:155], v120, s[20:21] offset:2048 sc1
    global_load_dwordx4 v[156:159], v120, s[20:21] offset:3072 sc1
    s_waitcnt vmcnt(5)
    s_branch L_o2
L_r3:
    s_cmp_eq_u32 s66, 0
    s_cbranch_scc1 L_b3
    s_sub_u32 s66, s66, 1
    global_load_dwordx4 v[140:143], v120, s[20:21] offset:-1024 sc1
    global_load_dwordx4 v[144:147], v120, s[20:21] offset:0 sc1
    global_load_dwordx4 v[148:151], v120, s[20:21] offset:1024 sc1
    global_load_dwordx4 v[152:155], v120, s[20:21] offset:2048 sc1
    global_load_dwordx4 v[156:159], v120, s[20:21] offset:3072 sc1
    s_waitcnt vmcnt(4)
    s_branch L_o3
L_r4:
    s_cmp_eq_u32 s66, 0
    s_cbranch_scc1 L_b4
    s_sub_u32 s66, s66, 1
    global_load_dwordx4 v[144:147], v120, s[20:21] offset:0 sc1
    global_load_dwordx4 v[148:151], v120, s[20:21] offset:1024 sc1
    global_load_dwordx4 v[152:155], v120, s[20:21] offset:2048 sc1
    global_load_dwordx4 v[156:159], v120, s[20:21] offset:3072 sc1
    s_waitcnt vmcnt(3)
    s_branch L_o4
L_r5:
    s_cmp_eq_u32 s66, 0
    s_cbranch_scc1 L_b5
    s_sub_u32 s66, s66, 1
    global_load_dwordx4 v[148:151], v120, s[20:21] offset:1024 sc1
    global_load_dwordx4 v[152:155], v120, s[20:21] offset:2048 sc1
    global_load_dwordx4 v[156:159], v120, s[20:21] offset:3072 sc1
    s_waitcnt vmcnt(2)
    s_branch L_o5
L_r6:
    s_cmp_eq_u32 s66, 0
    s_cbranch_scc1 L_b6
    s_sub_u32 s66, s66, 1
    global_load_dwordx4 v[152:155], v120, s[20:21] offset:2048 sc1
    global_load_dwordx4 v[156:159], v120, s[20:21] offset:3072 sc1
    s_waitcnt vmcnt(1)
    s_branch L_o6
L_r7:
    s_cmp_eq_u32 s66, 0
    s_cbranch_scc1 L_b7
    s_sub_u32 s66, s66, 1
    global_load_dwordx4 v[156:159], v120, s[20:21] offset:3072 sc1
    s_waitcnt vmcnt(0)
    s_branch L_o7
L_slow:
    s_cmp_lg_u32 s67, 0
    s_cbranch_scc1 L_ok
    s_mov_b32 s67, 1
    s_waitcnt vmcnt(0)
    v_add_u32 v104, 262144, v1
    v_mov_b32 v105, 0xff800000
    s_movk_i32 s31, 63
L_s1:
    global_load_dwordx4 v[128:131], v104, s[20:21] sc1
    global_load_dwordx4 v[132:135], v104, s[20:21] offset:1024 sc1
    v_add_u32 v104, 4096, v104
    s_waitcnt vmcnt(0)
    v_mfma_f32_32x32x16_bf16 v[72:87], v[128:131], v[32:35], 0
    v_mfma_f32_32x32x16_bf16 v[72:87], v[132:135], v[36:39], v[72:87]
    s_nop 7
    s_nop 3
    v_max3_f32 v105, v72, v73, v105
    v_max3_f32 v105, v74, v75, v105
    v_max3_f32 v105, v76, v77, v105
    v_max3_f32 v105, v78, v79, v105
    v_max3_f32 v105, v80, v81, v105
    v_max3_f32 v105, v82, v83, v105
    v_max3_f32 v105, v84, v85, v105
    v_max3_f32 v105, v86, v87, v105
    s_sub_u32 s31, s31, 1
    s_cbranch_scc0 L_s1
    v_mov_b32 v106, v105
    s_nop 1
    v_permlane32_swap_b32 v105, v106
    v_max_f32 v105, v105, v106
    v_mul_f32 v88, -1.0, v105
    v_mov_b32 v16, 0
    v_mul_f32 v89, -1.0, v105
    v_mov_b32 v17, 0
    v_mul_f32 v90, -1.0, v105
    v_mov_b32 v18, 0
    v_mul_f32 v91, -1.0, v105
    v_mov_b32 v19, 0
    v_mul_f32 v92, -1.0, v105
    v_mov_b32 v20, 0
    v_mul_f32 v93, -1.0, v105
    v_mov_b32 v21, 0
    v_mul_f32 v94, -1.0, v105
    v_mov_b32 v22, 0
    v_mul_f32 v95, -1.0, v105
    v_mov_b32 v23, 0
    v_mul_f32 v96, -1.0, v105
    v_mov_b32 v24, 0
    v_mul_f32 v97, -1.0, v105
    v_mov_b32 v25, 0
    v_mul_f32 v98, -1.0, v105
    v_mov_b32 v26, 0
    v_mul_f32 v99, -1.0, v105
    v_mov_b32 v27, 0
    v_mul_f32 v100, -1.0, v105
    v_mov_b32 v28, 0
    v_mul_f32 v101, -1.0, v105
    v_mov_b32 v29, 0
    v_mul_f32 v102, -1.0, v105
    v_mov_b32 v30, 0
    v_mul_f32 v103, -1.0, v105
    v_mov_b32 v31, 0
    v_add_u32 v104, 262144, v1
    s_movk_i32 s31, 63
L_s2:
    global_load_dwordx4 v[128:131], v104, s[20:21] sc1
    global_load_dwordx4 v[132:135], v104, s[20:21] offset:1024 sc1
    global_load_dwordx4 v[136:139], v104, s[20:21] offset:2048 sc1
    global_load_dwordx4 v[140:143], v104, s[20:21] offset:3072 sc1
    v_add_u32 v104, 4096, v104
    s_waitcnt vmcnt(0)
    v_mfma_f32_32x32x16_bf16 v[72:87], v[128:131], v[32:35], v[88:103]
    v_mfma_f32_32x32x16_bf16 v[72:87], v[132:135], v[36:39], v[72:87]
    s_nop 7
    s_nop 3
    v_exp_f32 v72, v72
    v_exp_f32 v73, v73
    v_exp_f32 v74, v74
    v_exp_f32 v75, v75
    v_exp_f32 v76, v76
    v_exp_f32 v77, v77
    v_exp_f32 v78, v78
    v_exp_f32 v79, v79
    v_exp_f32 v80, v80
    v_exp_f32 v81, v81
    v_exp_f32 v82, v82
    v_exp_f32 v83, v83
    v_exp_f32 v84, v84
    v_exp_f32 v85, v85
    v_exp_f32 v86, v86
    v_exp_f32 v87, v87
    v_smfmac_f32_32x32x32_bf16 v[16:31], v[136:139], v[72:79], v2
    s_nop 0
    v_smfmac_f32_32x32x32_bf16 v[16:31], v[140:143], v[80:87], v2
    s_nop 7
    s_nop 7
    s_sub_u32 s31, s31, 1
    s_cbranch_scc0 L_s2
    v_rcp_f32 v74, v20
    s_nop 0
    s_branch L_norm
.section .rodata,"a"
.p2align 6
.amdhsa_kernel concat_heads__grouped_kv_mqa__spectral_fnet__prompt_kernel
  .amdhsa_next_free_vgpr 512
  .amdhsa_next_free_sgpr 102
  .amdhsa_accum_offset 256
  .amdhsa_group_segment_fixed_size 0
  .amdhsa_kernarg_size 104
  .amdhsa_user_sgpr_count 2
  .amdhsa_user_sgpr_kernarg_segment_ptr 1
  .amdhsa_system_sgpr_workgroup_id_x 1
.end_amdhsa_kernel
```
